```python
import torch

def _softmax(x, axis=-1):
    return torch.softmax(x, dim=axis)
def _gelu(x):
    return torch.nn.functional.gelu(x, approximate="tanh")
def _silu(x):
    return torch.nn.functional.silu(x)
def _sigmoid(x):
    return torch.sigmoid(x)
def _layernorm(x, axis=-1, eps=1e-5):
    m = x.mean(dim=axis, keepdim=True)
    v = x.var(dim=axis, keepdim=True, unbiased=False)
    return (x - m) / torch.sqrt(v + eps)
def _scatter_add(tgt, idx, src, axis=0):
    return tgt.clone().index_add_(axis, idx, src)
def _segment_sum(src, seg, n):
    out = torch.zeros((n,) + src.shape[1:], dtype=src.dtype)
    return out.index_add_(0, seg, src)
def _pad(x, pw):
    flat = tuple(v for pair in reversed(pw) for v in pair)
    return torch.nn.functional.pad(x, flat)

kernel_name = 'gated_mix__ssm_conv_s4__dense_activation_relu__prompt'

def setup_inputs():

    _w = (lambda a: (lambda t: t.to(torch.bfloat16) if t.is_floating_point() else t)(torch.as_tensor(a)))
    def _A_setup():
        B, L, D, N = 1, 2048, 640, 128
        A_re = -(lambda _x: torch.exp(torch.as_tensor(_x)))((lambda *s: torch.randn(*s, dtype=torch.bfloat16) * 3.2)(D, N))
        A_im = torch.pi * (lambda *s: torch.randn(*s, dtype=torch.bfloat16) * 0.2)(D, N)
        B_re = (lambda *s: torch.randn(*s, dtype=torch.bfloat16) * 0.4)(D, N)
        B_im = (lambda *s: torch.randn(*s, dtype=torch.bfloat16) * 0.4)(D, N)
        C_re = (lambda *s: torch.randn(*s, dtype=torch.bfloat16) * 0.4)(D, N)
        C_im = (lambda *s: torch.randn(*s, dtype=torch.bfloat16) * 0.4)(D, N)
        log_dt = (lambda *s: torch.randn(*s, dtype=torch.bfloat16) * 0.2)(D) * 0.5 - 4.0
        Dskip = (lambda *s: torch.randn(*s, dtype=torch.bfloat16) * 0.4)(D)
        return {
            "u": _w((lambda *s: torch.randn(*s, dtype=torch.bfloat16) * 0.05)(B, L, D)),
            "A_re": _w(A_re),
            "A_im": _w(A_im),
            "B_re": _w(B_re),
            "B_im": _w(B_im),
            "C_re": _w(C_re),
            "C_im": _w(C_im),
            "log_dt": _w(log_dt),
            "Dskip": _w(Dskip),
        }
    _A_in = _A_setup()

    def _B_setup():
        B, S, D, Dff = 1, 2048, 640, 1728
        return {
            "x": _w((lambda *s: torch.randn(*s, dtype=torch.bfloat16) * 0.05)(B, S, D)),
            "w1": _w((lambda *s: torch.randn(*s, dtype=torch.bfloat16) * 0.05)(D, Dff)),
            "w2": _w((lambda *s: torch.randn(*s, dtype=torch.bfloat16) * 0.05)(Dff, D)),
        }
    _B_in = _B_setup()

    return {
        "A_u": _A_in["u"],
        "A_A_re": _A_in["A_re"],
        "A_A_im": _A_in["A_im"],
        "A_B_re": _A_in["B_re"],
        "A_B_im": _A_in["B_im"],
        "A_C_re": _A_in["C_re"],
        "A_C_im": _A_in["C_im"],
        "A_log_dt": _A_in["log_dt"],
        "A_Dskip": _A_in["Dskip"],
        "B_x": _B_in["x"],
        "B_w1": _B_in["w1"],
        "B_w2": _B_in["w2"],
        "gate_w": _w((lambda *s: torch.randn(*s, dtype=torch.bfloat16) * 0.05)(640) * 16.0),
    }

def reference(A_u, A_A_re, A_A_im, A_B_re, A_B_im, A_C_re, A_C_im, A_log_dt, A_Dskip, B_x, B_w1, B_w2, gate_w):
    def _A_ref(u, A_re, A_im, B_re, B_im, C_re, C_im, log_dt, Dskip):
        Bsz, L, D = u.shape
        dt = torch.exp(log_dt)[:, None]
        A = A_re + 1j * A_im
        Bc = B_re + 1j * B_im
        Cc = C_re + 1j * C_im
        logdA = dt * A
        dB = dt * Bc
        l = (lambda x, dt: x.to(dt))(torch.arange(L), A_re.dtype)
        P = torch.exp(logdA[:, :, None] * l[None, None, :])
        K = torch.einsum("dn,dnl,dn->dl", Cc, P, dB).real
        L2 = 2 * L
        Kp = _pad(K, ((0, 0), (0, L)))
        up = (lambda x, *d: x.permute(*d))(u, 0, 2, 1)
        up = _pad(up, ((0, 0), (0, 0), (0, L)))
        Kf = (lambda x, axes=(-2,-1): torch.fft.rfft2(x.float(), dim=axes))(Kp[:, None, :], axes=(-2, -1))
        Uf = (lambda x, axes=(-2,-1): torch.fft.rfft2(x.float(), dim=axes))(up[:, :, None, :], axes=(-2, -1))
        Yf = Uf * Kf[None, :, :, :]
        y = (lambda x, s, axes=(-2,-1): torch.fft.irfft2(x, s=s, dim=axes).to(torch.bfloat16))(Yf, (1, L2), axes=(-2, -1))[:, :, 0, :L]
        y = (lambda x, *d: x.permute(*d))(y, 0, 2, 1) + u * Dskip[None, None, :]
        return y

    def _B_ref(x, w1, w2):
        h = torch.einsum("bsd,df->bsf", x, w1)
        zero = torch.zeros_like(h)
        h = torch.maximum(h, zero)
        return torch.einsum("bsf,fd->bsd", h, w2)

    x = A_u
    g = _sigmoid((x * gate_w).sum(-1, keepdims=True))
    a = _A_ref(x, A_A_re, A_A_im, A_B_re, A_B_im, A_C_re, A_C_im, A_log_dt, A_Dskip)
    b = _B_ref(x, B_w1, B_w2)
    return g * a + (1 - g) * b
```

```asm
; @launch grid=(256,1,1) block=(256,1,1) lds=163840
.amdgcn_target "amdgcn-amd-amdhsa--gfx950"
.text
.globl gated_mix__ssm_conv_s4__dense_activation_relu__prompt_kernel
.p2align 8
.type gated_mix__ssm_conv_s4__dense_activation_relu__prompt_kernel,@function
gated_mix__ssm_conv_s4__dense_activation_relu__prompt_kernel:
s_cmp_ge_u32 s2, 256
s_cbranch_scc1 Lend
s_load_dwordx16 s[16:31], s[0:1], 0
s_load_dwordx16 s[32:47], s[0:1], 64
s_getpc_b64 s[88:89]
Lpc:
v_lshrrev_b32 v6, 6, v0
v_and_b32 v1, 63, v0
v_readfirstlane_b32 s3, v6
v_and_b32 v2, 15, v0
v_bfe_u32 v3, v0, 4, 2
v_lshlrev_b32 v5, 4, v1
s_and_b32 s4, s2, 7
s_lshr_b32 s5, s2, 3
s_lshl2_add_u32 s73, s5, s3
s_mul_i32 s73, s73, 384
v_and_b32_e64 v6, 3, v0
v_lshl_add_u32 v6, v6, 7, s73
v_min_u32 v6, Lend-Lpc, v6
global_load_dword v62, v6, s[88:89]
v_mov_b32_e64 v58, 0
s_lshr_b32 s6, s4, 1
s_and_b32 s7, s4, 1
s_lshr_b32 s73, s5, 3
s_lshl2_add_u32 s73, s6, s73
s_lshl1_add_u32 s10, s73, s7
s_and_b32 s11, s5, 7
s_mul_i32 s93, s11, 2
s_add_u32 s93, s93, s3
s_and_b32 s93, s93, 3
s_lshl_b32 s72, s3, 12
s_lshl2_add_u32 s101, s7, s3
s_mul_i32 s101, s101, 7
s_mul_i32 s84, s11, 286720
s_lshl_b32 s73, s101, 10
s_add_u32 s84, s84, s73
s_add_u32 s84, s84, 7340032
s_mov_b32 s50, 2621440
s_mov_b32 s51, 0x20000
s_mov_b32 s54, 2211840
s_mov_b32 s55, 0x20000
s_mov_b32 s58, 20447232
s_mov_b32 s59, 0x20000
s_mov_b32 s62, 2621440
s_mov_b32 s63, 0x20000
s_mov_b32 s66, 0
s_mov_b32 s67, 0x20000
s_mov_b32 s98, 2211840
s_mov_b32 s99, 0x20000
s_mov_b32 s83, 0
s_cmp_lt_u32 s5, 4
s_cbranch_scc1 Lfree
s_sub_u32 s5, s5, 4
s_and_b32 s73, s5, 3
s_lshl2_add_u32 s8, s6, s73
s_lshr_b32 s74, s5, 2
s_mul_i32 s9, s7, 7
s_add_u32 s9, s9, s74
s_mul_i32 s73, s73, 5
s_lshr_b32 s73, s73, 1
s_add_u32 s12, s73, s7
s_lshl_b32 s73, s74, 2
s_lshr_b32 s73, 0x5186420, s73
s_and_b32 s73, s73, 15
s_add_u32 s12, s12, s73
s_cmp_ge_u32 s12, 10
s_cselect_b32 s73, 10, 0
s_sub_u32 s12, s12, s73
s_cmp_lt_u32 s74, 5
s_cselect_b32 s85, 1, 0
s_mov_b32 s13, s12
s_mul_i32 s80, s4, 28
s_add_u32 s80, s80, s5
s_mul_i32 s80, s80, 3
s_add_u32 s80, s80, s3
s_cmp_lt_u32 s80, 640
s_cselect_b32 s15, 20447232, 0
s_min_u32 s80, s80, 639
s_cmp_eq_u32 s3, 3
s_cselect_b32 s87, 0, s3
s_mul_i32 s87, s87, 12288
s_add_u32 s87, s87, 98304
s_lshl_b32 s73, s80, 8
v_lshl_add_u32 v63, v1, 2, s73
v_lshrrev_b32 v6, 3, v1
v_mul_u32_u24 v7, 1280, v6
v_and_b32 v6, 7, v1
v_xor_b32 v6, v6, v3
v_lshl_add_u32 v8, v6, 4, v7
v_xor_b32_e64 v9, 64, v8
v_add_u32 v10, 18432, v8
v_add_u32 v11, 27648, v9
v_add_u32 v9, 9216, v9
v_lshlrev_b32 v6, 1, v3
v_xor_b32 v6, v6, v2
v_mul_u32_u24 v7, 3456, v3
v_lshl_add_u32 v12, v6, 4, v7
v_xor_b32_e64 v6, 8, v6
v_lshl_add_u32 v14, v6, 4, v7
s_cmp_eq_u32 s9, 13
s_cselect_b32 s73, 8, 0
v_and_b32_e64 v6, s73, v2
v_lshl_add_u32 v12, v6, 27, v12
v_xor_b32_e64 v6, s73, v6
v_lshl_add_u32 v14, v6, 27, v14
v_add_u32 v13, 12800, v12
v_add_u32 v15, 38400, v14
v_add_u32 v14, 25600, v14
s_lshr_b32 s73, s3, 1
s_lshl1_add_u32 s14, s9, s73
s_lshl2_add_u32 s70, s8, s3
s_mul_i32 s70, s70, 40960
s_lshl_b32 s73, s12, 7
s_add_u32 s70, s70, s73
s_lshl2_add_u32 s71, s12, s3
s_mul_i32 s71, s71, 55296
s_lshl_b32 s73, s9, 8
s_add_u32 s71, s71, s73
s_cmp_eq_u32 s3, 3
s_cbranch_scc1 Lbeta
s_waitcnt lgkmcnt(0)
s_cmp_lg_u32 s14, 27
s_cbranch_scc1 Lng_1
s_nop 0
global_load_dwordx4 v[144:147], v5, s[40:41]
v_add_u32 v134, 1024, v5
v_min_u32 v134, 0x4f0, v134
global_load_dwordx4 v[148:151], v134, s[40:41]
Lng_1:
global_load_dword v128, v63, s[18:19] nt
global_load_dword v129, v63, s[20:21] nt
global_load_dword v130, v63, s[22:23] nt
global_load_dword v131, v63, s[24:25] nt
global_load_dword v132, v63, s[26:27] nt
global_load_dword v133, v63, s[28:29] nt
s_barrier
s_and_b32 s73, s80, 0xfffe
s_lshl_b32 s73, s73, 1
s_load_dword s81, s[30:31], s73
s_load_dword s82, s[32:33], s73
s_load_dwordx2 s[68:69], s[46:47], 0
s_mov_b64 s[48:49], s[16:17]
s_mov_b64 s[52:53], s[36:37]
s_mov_b64 s[56:57], s[46:47]
s_mov_b64 s[60:61], s[42:43]
s_mov_b64 s[64:65], s[46:47]
s_mov_b64 s[96:97], s[38:39]
s_add_u32 m0, s72, 16384
s_nop 0
buffer_load_dwordx4 v12, s[52:55], s71 offen offset:0 lds
buffer_load_dwordx4 v13, s[52:55], s71 offen offset:1024 lds
buffer_load_dwordx4 v14, s[52:55], s71 offen offset:2048 lds
buffer_load_dwordx4 v15, s[52:55], s71 offen offset:3072 lds
v_add_u32 v48, s87, v5
v_lshl_add_u32 v50, v1, 3, s87
v_mov_b32 v64, 0
v_mov_b32 v65, 0
v_mov_b32 v66, 0
v_mov_b32 v67, 0
ds_write_b128 v48, v[64:67] offset:8704
ds_write_b128 v48, v[64:67] offset:9728
ds_write_b128 v48, v[64:67] offset:10752
ds_write_b64 v50, v[64:65] offset:11776
v_mul_u32_u24 v6, 544, v2
v_lshl_add_u32 v6, v3, 4, v6
v_add_u32 v49, s87, v6
s_and_b32 s73, s3, 1
s_lshl_b32 s73, s73, 13
v_lshrrev_b32 v6, 1, v2
v_xor_b32_e64 v6, v6, v3
v_lshl_add_u32 v7, v2, 7, s73
v_lshl_add_u32 v16, v6, 4, v7
v_xor_b32_e64 v17, 64, v16
v_add_u32 v18, 0x10000, v16
v_add_u32 v19, 0x10000, v17
v_lshrrev_b32 v6, 2, v2
v_and_b32 v7, 1, v3
v_lshl_or_b32 v7, v7, 2, v6
v_lshl_add_u32 v6, v3, 3, v6
v_lshlrev_b32_e64 v6, 8, v6
v_lshl_add_u32 v6, v7, 5, v6
v_and_b32_e64 v7, 3, v2
v_lshl_add_u32 v20, v7, 3, v6
s_lshr_b32 s74, s3, 1
s_lshl_b32 s74, s74, 7
v_xor_b32 v20, s74, v20
v_xor_b32 v21, 32, v20
v_xor_b32_e64 v22, 64, v20
v_xor_b32 v23, 96, v20
v_add_u32 v24, 0x10000, v20
v_add_u32 v25, 0x10000, v21
v_add_u32 v26, 0x10000, v22
v_add_u32 v27, 0x10000, v23
s_add_u32 s12, s12, 1
s_cmp_eq_u32 s12, 10
s_cselect_b32 s78, 9, -1
s_mul_i32 s79, s78, 128
s_sub_u32 s70, s70, s79
s_mul_i32 s79, s78, 221184
s_sub_u32 s71, s71, s79
s_cmp_eq_u32 s12, 10
s_cselect_b32 s12, 0, s12
s_add_u32 s12, s12, 1
s_cmp_eq_u32 s12, 10
s_cselect_b32 s78, 9, -1
s_mul_i32 s79, s78, 128
s_sub_u32 s70, s70, s79
s_mul_i32 s79, s78, 221184
s_sub_u32 s71, s71, s79
s_cmp_eq_u32 s12, 10
s_cselect_b32 s12, 0, s12
s_waitcnt lgkmcnt(0)
s_mul_i32 s68, s68, 0x9e3779b1
s_add_u32 s68, s68, 0x7f4a7c15
s_mul_i32 s69, s69, 0x85ebca6b
s_add_u32 s69, s69, s68
s_or_b32 s69, s69, 1
v_mov_b32 v60, s68
v_mov_b32 v61, s69
s_lshl_b32 s73, s81, 16
s_and_b32 s74, s81, 0xffff0000
s_bitcmp1_b32 s80, 0
s_cselect_b32 s81, s74, s73
s_lshl_b32 s73, s82, 16
s_and_b32 s74, s82, 0xffff0000
s_bitcmp1_b32 s80, 0
s_cselect_b32 s82, s74, s73
v_mov_b32 v66, s81
v_mul_f32 v67, 0x3fb8aa3b, v66
v_fmac_f32 v67, 0x32a5705f, v66
v_exp_f32 v67, v67
s_nop 0
v_cvt_pk_bf16_f32 v67, v67, v67
v_lshlrev_b32 v64, 16, v67
v_mov_b32_e64 v65, v64
s_waitcnt vmcnt(4)
s_cmp_lg_u32 s14, 27
s_cbranch_scc1 Lng_2
v_add_u32 v6, 160512, v5
v_add_u32 v134, 160512, v134
ds_write_b128 v6, v[144:147]
ds_write_b128 v134, v[148:151]
Lng_2:
v_lshlrev_b32 v152, 16, v128
v_lshlrev_b32 v153, 16, v129
v_lshlrev_b32 v154, 16, v130
v_lshlrev_b32 v155, 16, v131
v_lshlrev_b32 v156, 16, v132
v_lshlrev_b32 v157, 16, v133
v_pk_mul_f32 v[152:153], v[152:153], v[64:65]
v_mul_f32 v152, 0x3fb8aa3b, v152
v_mul_f32_e64 v153, 0.15915494, v153
v_and_b32 v158, 0xffff0000, v128
v_and_b32 v159, 0xffff0000, v129
v_and_b32 v160, 0xffff0000, v130
v_and_b32 v161, 0xffff0000, v131
v_and_b32 v162, 0xffff0000, v132
v_and_b32 v163, 0xffff0000, v133
v_pk_mul_f32 v[158:159], v[158:159], v[64:65]
v_mul_f32 v158, 0x3fb8aa3b, v158
v_mul_f32_e64 v159, 0.15915494, v159
v_mul_f32 v166, 0x41000000, v152
v_mul_f32 v167, 0x41000000, v153
v_exp_f32 v166, v166
v_fract_f32 v167, v167
v_mul_f32 v170, 0x41000000, v158
v_mul_f32 v171, 0x41000000, v159
v_exp_f32 v170, v170
v_fract_f32 v171, v171
v_cos_f32 v164, v167
v_sin_f32 v165, v167
v_cos_f32 v168, v171
v_sin_f32 v169, v171
v_pk_mul_f32 v[164:165], v[164:165], v[166:167] op_sel:[0,0] op_sel_hi:[1,0]
v_pk_mul_f32 v[168:169], v[168:169], v[170:171] op_sel:[0,0] op_sel_hi:[1,0]
v_pk_mul_f32 v[172:173], v[156:157], v[154:155] op_sel:[0,0] op_sel_hi:[1,0]
v_pk_mul_f32 v[174:175], v[162:163], v[160:161] op_sel:[0,0] op_sel_hi:[1,0]
v_pk_fma_f32 v[172:173], v[156:157], v[154:155], v[172:173] op_sel:[1,1,0] op_sel_hi:[0,1,1] neg_lo:[1,0,0]
v_pk_fma_f32 v[174:175], v[162:163], v[160:161], v[174:175] op_sel:[1,1,0] op_sel_hi:[0,1,1] neg_lo:[1,0,0]
v_pk_mul_f32 v[172:173], v[172:173], v[64:65] neg_hi:[0,1]
v_pk_mul_f32 v[174:175], v[174:175], v[64:65] neg_hi:[0,1]
v_pk_mul_f32 v[176:177], v[172:173], v[164:165] op_sel:[0,0] op_sel_hi:[1,0]
v_pk_mul_f32 v[178:179], v[174:175], v[168:169] op_sel:[0,0] op_sel_hi:[1,0]
v_pk_fma_f32 v[176:177], v[172:173], v[164:165], v[176:177] op_sel:[1,1,0] op_sel_hi:[0,1,1] neg_hi:[1,0,0]
v_pk_fma_f32 v[178:179], v[174:175], v[168:169], v[178:179] op_sel:[1,1,0] op_sel_hi:[0,1,1] neg_hi:[1,0,0]
v_cvt_pk_bf16_f32 v66, v172, v173
v_cvt_pk_bf16_f32 v67, v174, v175
ds_write_b64 v50, v[66:67] offset:0
v_pk_mul_f32 v[180:181], v[176:177], v[164:165] op_sel:[0,0] op_sel_hi:[1,0]
v_pk_mul_f32 v[182:183], v[178:179], v[168:169] op_sel:[0,0] op_sel_hi:[1,0]
v_pk_fma_f32 v[180:181], v[176:177], v[164:165], v[180:181] op_sel:[1,1,0] op_sel_hi:[0,1,1] neg_hi:[1,0,0]
v_pk_fma_f32 v[182:183], v[178:179], v[168:169], v[182:183] op_sel:[1,1,0] op_sel_hi:[0,1,1] neg_hi:[1,0,0]
v_cvt_pk_bf16_f32 v68, v176, v177
v_cvt_pk_bf16_f32 v69, v178, v179
ds_write_b64 v50, v[68:69] offset:544
v_pk_mul_f32 v[184:185], v[180:181], v[164:165] op_sel:[0,0] op_sel_hi:[1,0]
v_pk_mul_f32 v[186:187], v[182:183], v[168:169] op_sel:[0,0] op_sel_hi:[1,0]
v_pk_fma_f32 v[184:185], v[180:181], v[164:165], v[184:185] op_sel:[1,1,0] op_sel_hi:[0,1,1] neg_hi:[1,0,0]
v_pk_fma_f32 v[186:187], v[182:183], v[168:169], v[186:187] op_sel:[1,1,0] op_sel_hi:[0,1,1] neg_hi:[1,0,0]
v_cvt_pk_bf16_f32 v70, v180, v181
v_cvt_pk_bf16_f32 v71, v182, v183
ds_write_b64 v50, v[70:71] offset:1088
v_pk_mul_f32 v[188:189], v[184:185], v[164:165] op_sel:[0,0] op_sel_hi:[1,0]
v_pk_mul_f32 v[190:191], v[186:187], v[168:169] op_sel:[0,0] op_sel_hi:[1,0]
v_pk_fma_f32 v[188:189], v[184:185], v[164:165], v[188:189] op_sel:[1,1,0] op_sel_hi:[0,1,1] neg_hi:[1,0,0]
v_pk_fma_f32 v[190:191], v[186:187], v[168:169], v[190:191] op_sel:[1,1,0] op_sel_hi:[0,1,1] neg_hi:[1,0,0]
v_cvt_pk_bf16_f32 v72, v184, v185
v_cvt_pk_bf16_f32 v73, v186, v187
ds_write_b64 v50, v[72:73] offset:1632
v_pk_mul_f32 v[192:193], v[188:189], v[164:165] op_sel:[0,0] op_sel_hi:[1,0]
v_pk_mul_f32 v[194:195], v[190:191], v[168:169] op_sel:[0,0] op_sel_hi:[1,0]
v_pk_fma_f32 v[192:193], v[188:189], v[164:165], v[192:193] op_sel:[1,1,0] op_sel_hi:[0,1,1] neg_hi:[1,0,0]
v_pk_fma_f32 v[194:195], v[190:191], v[168:169], v[194:195] op_sel:[1,1,0] op_sel_hi:[0,1,1] neg_hi:[1,0,0]
v_cvt_pk_bf16_f32 v66, v188, v189
v_cvt_pk_bf16_f32 v67, v190, v191
ds_write_b64 v50, v[66:67] offset:2176
v_pk_mul_f32 v[196:197], v[192:193], v[164:165] op_sel:[0,0] op_sel_hi:[1,0]
v_pk_mul_f32 v[198:199], v[194:195], v[168:169] op_sel:[0,0] op_sel_hi:[1,0]
v_pk_fma_f32 v[196:197], v[192:193], v[164:165], v[196:197] op_sel:[1,1,0] op_sel_hi:[0,1,1] neg_hi:[1,0,0]
v_pk_fma_f32 v[198:199], v[194:195], v[168:169], v[198:199] op_sel:[1,1,0] op_sel_hi:[0,1,1] neg_hi:[1,0,0]
v_cvt_pk_bf16_f32 v68, v192, v193
v_cvt_pk_bf16_f32 v69, v194, v195
ds_write_b64 v50, v[68:69] offset:2720
v_pk_mul_f32 v[200:201], v[196:197], v[164:165] op_sel:[0,0] op_sel_hi:[1,0]
v_pk_mul_f32 v[202:203], v[198:199], v[168:169] op_sel:[0,0] op_sel_hi:[1,0]
v_pk_fma_f32 v[200:201], v[196:197], v[164:165], v[200:201] op_sel:[1,1,0] op_sel_hi:[0,1,1] neg_hi:[1,0,0]
v_pk_fma_f32 v[202:203], v[198:199], v[168:169], v[202:203] op_sel:[1,1,0] op_sel_hi:[0,1,1] neg_hi:[1,0,0]
v_cvt_pk_bf16_f32 v70, v196, v197
v_cvt_pk_bf16_f32 v71, v198, v199
ds_write_b64 v50, v[70:71] offset:3264
v_pk_mul_f32 v[204:205], v[200:201], v[164:165] op_sel:[0,0] op_sel_hi:[1,0]
v_pk_mul_f32 v[206:207], v[202:203], v[168:169] op_sel:[0,0] op_sel_hi:[1,0]
v_pk_fma_f32 v[204:205], v[200:201], v[164:165], v[204:205] op_sel:[1,1,0] op_sel_hi:[0,1,1] neg_hi:[1,0,0]
v_pk_fma_f32 v[206:207], v[202:203], v[168:169], v[206:207] op_sel:[1,1,0] op_sel_hi:[0,1,1] neg_hi:[1,0,0]
v_cvt_pk_bf16_f32 v72, v200, v201
v_cvt_pk_bf16_f32 v73, v202, v203
ds_write_b64 v50, v[72:73] offset:3808
v_pk_mul_f32 v[208:209], v[204:205], v[164:165] op_sel:[0,0] op_sel_hi:[1,0]
v_pk_mul_f32 v[210:211], v[206:207], v[168:169] op_sel:[0,0] op_sel_hi:[1,0]
v_pk_fma_f32 v[208:209], v[204:205], v[164:165], v[208:209] op_sel:[1,1,0] op_sel_hi:[0,1,1] neg_hi:[1,0,0]
v_pk_fma_f32 v[210:211], v[206:207], v[168:169], v[210:211] op_sel:[1,1,0] op_sel_hi:[0,1,1] neg_hi:[1,0,0]
v_cvt_pk_bf16_f32 v66, v204, v205
v_cvt_pk_bf16_f32 v67, v206, v207
ds_write_b64 v50, v[66:67] offset:4352
v_pk_mul_f32 v[212:213], v[208:209], v[164:165] op_sel:[0,0] op_sel_hi:[1,0]
v_pk_mul_f32 v[214:215], v[210:211], v[168:169] op_sel:[0,0] op_sel_hi:[1,0]
v_pk_fma_f32 v[212:213], v[208:209], v[164:165], v[212:213] op_sel:[1,1,0] op_sel_hi:[0,1,1] neg_hi:[1,0,0]
v_pk_fma_f32 v[214:215], v[210:211], v[168:169], v[214:215] op_sel:[1,1,0] op_sel_hi:[0,1,1] neg_hi:[1,0,0]
v_cvt_pk_bf16_f32 v68, v208, v209
v_cvt_pk_bf16_f32 v69, v210, v211
ds_write_b64 v50, v[68:69] offset:4896
v_pk_mul_f32 v[216:217], v[212:213], v[164:165] op_sel:[0,0] op_sel_hi:[1,0]
v_pk_mul_f32 v[218:219], v[214:215], v[168:169] op_sel:[0,0] op_sel_hi:[1,0]
v_pk_fma_f32 v[216:217], v[212:213], v[164:165], v[216:217] op_sel:[1,1,0] op_sel_hi:[0,1,1] neg_hi:[1,0,0]
v_pk_fma_f32 v[218:219], v[214:215], v[168:169], v[218:219] op_sel:[1,1,0] op_sel_hi:[0,1,1] neg_hi:[1,0,0]
v_cvt_pk_bf16_f32 v70, v212, v213
v_cvt_pk_bf16_f32 v71, v214, v215
ds_write_b64 v50, v[70:71] offset:5440
v_pk_mul_f32 v[220:221], v[216:217], v[164:165] op_sel:[0,0] op_sel_hi:[1,0]
v_pk_mul_f32 v[222:223], v[218:219], v[168:169] op_sel:[0,0] op_sel_hi:[1,0]
v_pk_fma_f32 v[220:221], v[216:217], v[164:165], v[220:221] op_sel:[1,1,0] op_sel_hi:[0,1,1] neg_hi:[1,0,0]
v_pk_fma_f32 v[222:223], v[218:219], v[168:169], v[222:223] op_sel:[1,1,0] op_sel_hi:[0,1,1] neg_hi:[1,0,0]
v_cvt_pk_bf16_f32 v72, v216, v217
v_cvt_pk_bf16_f32 v73, v218, v219
ds_write_b64 v50, v[72:73] offset:5984
v_pk_mul_f32 v[74:75], v[220:221], v[164:165] op_sel:[0,0] op_sel_hi:[1,0]
v_pk_mul_f32 v[76:77], v[222:223], v[168:169] op_sel:[0,0] op_sel_hi:[1,0]
v_pk_fma_f32 v[74:75], v[220:221], v[164:165], v[74:75] op_sel:[1,1,0] op_sel_hi:[0,1,1] neg_hi:[1,0,0]
v_pk_fma_f32 v[76:77], v[222:223], v[168:169], v[76:77] op_sel:[1,1,0] op_sel_hi:[0,1,1] neg_hi:[1,0,0]
v_cvt_pk_bf16_f32 v66, v220, v221
v_cvt_pk_bf16_f32 v67, v222, v223
ds_write_b64 v50, v[66:67] offset:6528
v_pk_mul_f32 v[78:79], v[74:75], v[164:165] op_sel:[0,0] op_sel_hi:[1,0]
v_pk_mul_f32 v[80:81], v[76:77], v[168:169] op_sel:[0,0] op_sel_hi:[1,0]
v_pk_fma_f32 v[78:79], v[74:75], v[164:165], v[78:79] op_sel:[1,1,0] op_sel_hi:[0,1,1] neg_hi:[1,0,0]
v_pk_fma_f32 v[80:81], v[76:77], v[168:169], v[80:81] op_sel:[1,1,0] op_sel_hi:[0,1,1] neg_hi:[1,0,0]
v_cvt_pk_bf16_f32 v68, v74, v75
v_cvt_pk_bf16_f32 v69, v76, v77
ds_write_b64 v50, v[68:69] offset:7072
v_pk_mul_f32 v[82:83], v[78:79], v[164:165] op_sel:[0,0] op_sel_hi:[1,0]
v_pk_mul_f32 v[84:85], v[80:81], v[168:169] op_sel:[0,0] op_sel_hi:[1,0]
v_pk_fma_f32 v[82:83], v[78:79], v[164:165], v[82:83] op_sel:[1,1,0] op_sel_hi:[0,1,1] neg_hi:[1,0,0]
v_pk_fma_f32 v[84:85], v[80:81], v[168:169], v[84:85] op_sel:[1,1,0] op_sel_hi:[0,1,1] neg_hi:[1,0,0]
v_cvt_pk_bf16_f32 v70, v78, v79
v_cvt_pk_bf16_f32 v71, v80, v81
ds_write_b64 v50, v[70:71] offset:7616
v_cvt_pk_bf16_f32 v72, v82, v83
v_cvt_pk_bf16_f32 v73, v84, v85
ds_write_b64 v50, v[72:73] offset:8160
ds_read_b128 a[0:3], v49 offset:0
ds_read_b128 a[4:7], v49 offset:64
ds_read_b128 a[8:11], v49 offset:128
ds_read_b128 a[12:15], v49 offset:192
ds_read_b128 a[16:19], v49 offset:256
ds_read_b128 a[20:23], v49 offset:320
ds_read_b128 a[24:27], v49 offset:384
ds_read_b128 a[28:31], v49 offset:448
v_exp_f32 v88, v152
v_fract_f32 v89, v153
v_exp_f32 v92, v158
v_fract_f32 v93, v159
v_cos_f32 v86, v89
v_sin_f32 v87, v89
v_cos_f32 v90, v93
v_sin_f32 v91, v93
v_pk_mul_f32 v[86:87], v[86:87], v[88:89] op_sel:[0,0] op_sel_hi:[1,0]
v_pk_mul_f32 v[90:91], v[90:91], v[92:93] op_sel:[0,0] op_sel_hi:[1,0]
v_mul_f32 v96, 0x43000000, v152
v_mul_f32 v97, 0x43000000, v153
v_exp_f32 v96, v96
v_fract_f32 v97, v97
v_mul_f32 v100, 0x43000000, v158
v_mul_f32 v101, 0x43000000, v159
v_exp_f32 v100, v100
v_fract_f32 v101, v101
v_cos_f32 v94, v97
v_sin_f32 v95, v97
v_cos_f32 v98, v101
v_sin_f32 v99, v101
v_pk_mul_f32 v[94:95], v[94:95], v[96:97] op_sel:[0,0] op_sel_hi:[1,0]
v_pk_mul_f32 v[98:99], v[98:99], v[100:101] op_sel:[0,0] op_sel_hi:[1,0]
v_pk_mul_f32 v[102:103], v[86:87], v[86:87] op_sel:[0,0] op_sel_hi:[1,0]
v_pk_mul_f32 v[104:105], v[90:91], v[90:91] op_sel:[0,0] op_sel_hi:[1,0]
v_pk_fma_f32 v[102:103], v[86:87], v[86:87], v[102:103] op_sel:[1,1,0] op_sel_hi:[0,1,1] neg_lo:[1,0,0]
v_pk_fma_f32 v[104:105], v[90:91], v[90:91], v[104:105] op_sel:[1,1,0] op_sel_hi:[0,1,1] neg_lo:[1,0,0]
v_cvt_pk_bf16_f32 v66, v86, v87
v_cvt_pk_bf16_f32 v67, v90, v91
ds_write_b64 v50, v[66:67] offset:0
v_pk_mul_f32 v[106:107], v[102:103], v[86:87] op_sel:[0,0] op_sel_hi:[1,0]
v_pk_mul_f32 v[108:109], v[104:105], v[90:91] op_sel:[0,0] op_sel_hi:[1,0]
v_pk_fma_f32 v[106:107], v[102:103], v[86:87], v[106:107] op_sel:[1,1,0] op_sel_hi:[0,1,1] neg_lo:[1,0,0]
v_pk_fma_f32 v[108:109], v[104:105], v[90:91], v[108:109] op_sel:[1,1,0] op_sel_hi:[0,1,1] neg_lo:[1,0,0]
v_cvt_pk_bf16_f32 v68, v102, v103
v_cvt_pk_bf16_f32 v69, v104, v105
ds_write_b64 v50, v[68:69] offset:544
v_pk_mul_f32 v[110:111], v[106:107], v[86:87] op_sel:[0,0] op_sel_hi:[1,0]
v_pk_mul_f32 v[112:113], v[108:109], v[90:91] op_sel:[0,0] op_sel_hi:[1,0]
v_pk_fma_f32 v[110:111], v[106:107], v[86:87], v[110:111] op_sel:[1,1,0] op_sel_hi:[0,1,1] neg_lo:[1,0,0]
v_pk_fma_f32 v[112:113], v[108:109], v[90:91], v[112:113] op_sel:[1,1,0] op_sel_hi:[0,1,1] neg_lo:[1,0,0]
v_cvt_pk_bf16_f32 v70, v106, v107
v_cvt_pk_bf16_f32 v71, v108, v109
ds_write_b64 v50, v[70:71] offset:1088
v_pk_mul_f32 v[114:115], v[110:111], v[86:87] op_sel:[0,0] op_sel_hi:[1,0]
v_pk_mul_f32 v[116:117], v[112:113], v[90:91] op_sel:[0,0] op_sel_hi:[1,0]
v_pk_fma_f32 v[114:115], v[110:111], v[86:87], v[114:115] op_sel:[1,1,0] op_sel_hi:[0,1,1] neg_lo:[1,0,0]
v_pk_fma_f32 v[116:117], v[112:113], v[90:91], v[116:117] op_sel:[1,1,0] op_sel_hi:[0,1,1] neg_lo:[1,0,0]
v_cvt_pk_bf16_f32 v72, v110, v111
v_cvt_pk_bf16_f32 v73, v112, v113
ds_write_b64 v50, v[72:73] offset:1632
v_pk_mul_f32 v[118:119], v[114:115], v[86:87] op_sel:[0,0] op_sel_hi:[1,0]
v_pk_mul_f32 v[120:121], v[116:117], v[90:91] op_sel:[0,0] op_sel_hi:[1,0]
v_pk_fma_f32 v[118:119], v[114:115], v[86:87], v[118:119] op_sel:[1,1,0] op_sel_hi:[0,1,1] neg_lo:[1,0,0]
v_pk_fma_f32 v[120:121], v[116:117], v[90:91], v[120:121] op_sel:[1,1,0] op_sel_hi:[0,1,1] neg_lo:[1,0,0]
v_cvt_pk_bf16_f32 v66, v114, v115
v_cvt_pk_bf16_f32 v67, v116, v117
ds_write_b64 v50, v[66:67] offset:2176
v_pk_mul_f32 v[122:123], v[118:119], v[86:87] op_sel:[0,0] op_sel_hi:[1,0]
v_pk_mul_f32 v[124:125], v[120:121], v[90:91] op_sel:[0,0] op_sel_hi:[1,0]
v_pk_fma_f32 v[122:123], v[118:119], v[86:87], v[122:123] op_sel:[1,1,0] op_sel_hi:[0,1,1] neg_lo:[1,0,0]
v_pk_fma_f32 v[124:125], v[120:121], v[90:91], v[124:125] op_sel:[1,1,0] op_sel_hi:[0,1,1] neg_lo:[1,0,0]
v_cvt_pk_bf16_f32 v68, v118, v119
v_cvt_pk_bf16_f32 v69, v120, v121
ds_write_b64 v50, v[68:69] offset:2720
v_cvt_pk_bf16_f32 v70, v122, v123
v_cvt_pk_bf16_f32 v71, v124, v125
ds_write_b64 v50, v[70:71] offset:3264
v_cvt_pk_bf16_f32 v72, v164, v165
v_cvt_pk_bf16_f32 v73, v168, v169
ds_write_b64 v50, v[72:73] offset:3808
v_pk_mul_f32 v[126:127], v[86:87], v[94:95] op_sel:[0,0] op_sel_hi:[1,0]
v_pk_mul_f32 v[166:167], v[90:91], v[98:99] op_sel:[0,0] op_sel_hi:[1,0]
v_pk_fma_f32 v[126:127], v[86:87], v[94:95], v[126:127] op_sel:[1,1,0] op_sel_hi:[0,1,1] neg_lo:[1,0,0]
v_pk_fma_f32 v[166:167], v[90:91], v[98:99], v[166:167] op_sel:[1,1,0] op_sel_hi:[0,1,1] neg_lo:[1,0,0]
v_cvt_pk_bf16_f32 v66, v126, v127
v_cvt_pk_bf16_f32 v67, v166, v167
ds_write_b64 v50, v[66:67] offset:4352
v_pk_mul_f32 v[170:171], v[102:103], v[94:95] op_sel:[0,0] op_sel_hi:[1,0]
v_pk_mul_f32 v[172:173], v[104:105], v[98:99] op_sel:[0,0] op_sel_hi:[1,0]
v_pk_fma_f32 v[170:171], v[102:103], v[94:95], v[170:171] op_sel:[1,1,0] op_sel_hi:[0,1,1] neg_lo:[1,0,0]
v_pk_fma_f32 v[172:173], v[104:105], v[98:99], v[172:173] op_sel:[1,1,0] op_sel_hi:[0,1,1] neg_lo:[1,0,0]
v_cvt_pk_bf16_f32 v68, v170, v171
v_cvt_pk_bf16_f32 v69, v172, v173
ds_write_b64 v50, v[68:69] offset:4896
v_pk_mul_f32 v[174:175], v[106:107], v[94:95] op_sel:[0,0] op_sel_hi:[1,0]
v_pk_mul_f32 v[176:177], v[108:109], v[98:99] op_sel:[0,0] op_sel_hi:[1,0]
v_pk_fma_f32 v[174:175], v[106:107], v[94:95], v[174:175] op_sel:[1,1,0] op_sel_hi:[0,1,1] neg_lo:[1,0,0]
v_pk_fma_f32 v[176:177], v[108:109], v[98:99], v[176:177] op_sel:[1,1,0] op_sel_hi:[0,1,1] neg_lo:[1,0,0]
v_cvt_pk_bf16_f32 v70, v174, v175
v_cvt_pk_bf16_f32 v71, v176, v177
ds_write_b64 v50, v[70:71] offset:5440
v_pk_mul_f32 v[178:179], v[110:111], v[94:95] op_sel:[0,0] op_sel_hi:[1,0]
v_pk_mul_f32 v[180:181], v[112:113], v[98:99] op_sel:[0,0] op_sel_hi:[1,0]
v_pk_fma_f32 v[178:179], v[110:111], v[94:95], v[178:179] op_sel:[1,1,0] op_sel_hi:[0,1,1] neg_lo:[1,0,0]
v_pk_fma_f32 v[180:181], v[112:113], v[98:99], v[180:181] op_sel:[1,1,0] op_sel_hi:[0,1,1] neg_lo:[1,0,0]
v_cvt_pk_bf16_f32 v72, v178, v179
v_cvt_pk_bf16_f32 v73, v180, v181
ds_write_b64 v50, v[72:73] offset:5984
v_pk_mul_f32 v[182:183], v[114:115], v[94:95] op_sel:[0,0] op_sel_hi:[1,0]
v_pk_mul_f32 v[184:185], v[116:117], v[98:99] op_sel:[0,0] op_sel_hi:[1,0]
v_pk_fma_f32 v[182:183], v[114:115], v[94:95], v[182:183] op_sel:[1,1,0] op_sel_hi:[0,1,1] neg_lo:[1,0,0]
v_pk_fma_f32 v[184:185], v[116:117], v[98:99], v[184:185] op_sel:[1,1,0] op_sel_hi:[0,1,1] neg_lo:[1,0,0]
v_cvt_pk_bf16_f32 v66, v182, v183
v_cvt_pk_bf16_f32 v67, v184, v185
ds_write_b64 v50, v[66:67] offset:6528
v_pk_mul_f32 v[186:187], v[118:119], v[94:95] op_sel:[0,0] op_sel_hi:[1,0]
v_pk_mul_f32 v[188:189], v[120:121], v[98:99] op_sel:[0,0] op_sel_hi:[1,0]
v_pk_fma_f32 v[186:187], v[118:119], v[94:95], v[186:187] op_sel:[1,1,0] op_sel_hi:[0,1,1] neg_lo:[1,0,0]
v_pk_fma_f32 v[188:189], v[120:121], v[98:99], v[188:189] op_sel:[1,1,0] op_sel_hi:[0,1,1] neg_lo:[1,0,0]
v_cvt_pk_bf16_f32 v68, v186, v187
v_cvt_pk_bf16_f32 v69, v188, v189
ds_write_b64 v50, v[68:69] offset:7072
v_pk_mul_f32 v[190:191], v[122:123], v[94:95] op_sel:[0,0] op_sel_hi:[1,0]
v_pk_mul_f32 v[192:193], v[124:125], v[98:99] op_sel:[0,0] op_sel_hi:[1,0]
v_pk_fma_f32 v[190:191], v[122:123], v[94:95], v[190:191] op_sel:[1,1,0] op_sel_hi:[0,1,1] neg_lo:[1,0,0]
v_pk_fma_f32 v[192:193], v[124:125], v[98:99], v[192:193] op_sel:[1,1,0] op_sel_hi:[0,1,1] neg_lo:[1,0,0]
v_cvt_pk_bf16_f32 v70, v190, v191
v_cvt_pk_bf16_f32 v71, v192, v193
ds_write_b64 v50, v[70:71] offset:7616
v_pk_mul_f32 v[194:195], v[164:165], v[94:95] op_sel:[0,0] op_sel_hi:[1,0]
v_pk_mul_f32 v[196:197], v[168:169], v[98:99] op_sel:[0,0] op_sel_hi:[1,0]
v_pk_fma_f32 v[194:195], v[164:165], v[94:95], v[194:195] op_sel:[1,1,0] op_sel_hi:[0,1,1] neg_lo:[1,0,0]
v_pk_fma_f32 v[196:197], v[168:169], v[98:99], v[196:197] op_sel:[1,1,0] op_sel_hi:[0,1,1] neg_lo:[1,0,0]
v_cvt_pk_bf16_f32 v72, v194, v195
v_cvt_pk_bf16_f32 v73, v196, v197
ds_write_b64 v50, v[72:73] offset:8160
ds_read_b128 a[32:35], v49 offset:0
ds_read_b128 a[36:39], v49 offset:64
ds_read_b128 a[40:43], v49 offset:128
ds_read_b128 a[44:47], v49 offset:192
ds_read_b128 a[48:51], v49 offset:256
ds_read_b128 a[52:55], v49 offset:320
ds_read_b128 a[56:59], v49 offset:384
ds_read_b128 a[60:63], v49 offset:448
v_pk_mul_f32 v[198:199], v[94:95], v[94:95] op_sel:[0,0] op_sel_hi:[1,0]
v_pk_mul_f32 v[200:201], v[98:99], v[98:99] op_sel:[0,0] op_sel_hi:[1,0]
v_pk_fma_f32 v[198:199], v[94:95], v[94:95], v[198:199] op_sel:[1,1,0] op_sel_hi:[0,1,1] neg_lo:[1,0,0]
v_pk_fma_f32 v[200:201], v[98:99], v[98:99], v[200:201] op_sel:[1,1,0] op_sel_hi:[0,1,1] neg_lo:[1,0,0]
v_pk_mul_f32 v[202:203], v[198:199], v[198:199] op_sel:[0,0] op_sel_hi:[1,0]
v_pk_mul_f32 v[204:205], v[200:201], v[200:201] op_sel:[0,0] op_sel_hi:[1,0]
v_pk_fma_f32 v[202:203], v[198:199], v[198:199], v[202:203] op_sel:[1,1,0] op_sel_hi:[0,1,1] neg_lo:[1,0,0]
v_pk_fma_f32 v[204:205], v[200:201], v[200:201], v[204:205] op_sel:[1,1,0] op_sel_hi:[0,1,1] neg_lo:[1,0,0]
v_pk_mul_f32 v[206:207], v[202:203], v[202:203] op_sel:[0,0] op_sel_hi:[1,0]
v_pk_mul_f32 v[208:209], v[204:205], v[204:205] op_sel:[0,0] op_sel_hi:[1,0]
v_pk_fma_f32 v[206:207], v[202:203], v[202:203], v[206:207] op_sel:[1,1,0] op_sel_hi:[0,1,1] neg_lo:[1,0,0]
v_pk_fma_f32 v[208:209], v[204:205], v[204:205], v[208:209] op_sel:[1,1,0] op_sel_hi:[0,1,1] neg_lo:[1,0,0]
v_pk_mul_f32 v[210:211], v[102:103], v[198:199] op_sel:[0,0] op_sel_hi:[1,0]
v_pk_mul_f32 v[212:213], v[104:105], v[200:201] op_sel:[0,0] op_sel_hi:[1,0]
v_pk_fma_f32 v[210:211], v[102:103], v[198:199], v[210:211] op_sel:[1,1,0] op_sel_hi:[0,1,1] neg_lo:[1,0,0]
v_pk_fma_f32 v[212:213], v[104:105], v[200:201], v[212:213] op_sel:[1,1,0] op_sel_hi:[0,1,1] neg_lo:[1,0,0]
v_cvt_pk_bf16_f32 v66, v210, v211
v_cvt_pk_bf16_f32 v67, v212, v213
ds_write_b64 v50, v[66:67] offset:0
v_pk_mul_f32 v[214:215], v[110:111], v[198:199] op_sel:[0,0] op_sel_hi:[1,0]
v_pk_mul_f32 v[216:217], v[112:113], v[200:201] op_sel:[0,0] op_sel_hi:[1,0]
v_pk_fma_f32 v[214:215], v[110:111], v[198:199], v[214:215] op_sel:[1,1,0] op_sel_hi:[0,1,1] neg_lo:[1,0,0]
v_pk_fma_f32 v[216:217], v[112:113], v[200:201], v[216:217] op_sel:[1,1,0] op_sel_hi:[0,1,1] neg_lo:[1,0,0]
v_cvt_pk_bf16_f32 v68, v214, v215
v_cvt_pk_bf16_f32 v69, v216, v217
ds_write_b64 v50, v[68:69] offset:544
v_pk_mul_f32 v[218:219], v[118:119], v[198:199] op_sel:[0,0] op_sel_hi:[1,0]
v_pk_mul_f32 v[220:221], v[120:121], v[200:201] op_sel:[0,0] op_sel_hi:[1,0]
v_pk_fma_f32 v[218:219], v[118:119], v[198:199], v[218:219] op_sel:[1,1,0] op_sel_hi:[0,1,1] neg_lo:[1,0,0]
v_pk_fma_f32 v[220:221], v[120:121], v[200:201], v[220:221] op_sel:[1,1,0] op_sel_hi:[0,1,1] neg_lo:[1,0,0]
v_cvt_pk_bf16_f32 v70, v218, v219
v_cvt_pk_bf16_f32 v71, v220, v221
ds_write_b64 v50, v[70:71] offset:1088
v_pk_mul_f32 v[222:223], v[164:165], v[198:199] op_sel:[0,0] op_sel_hi:[1,0]
v_pk_mul_f32 v[74:75], v[168:169], v[200:201] op_sel:[0,0] op_sel_hi:[1,0]
v_pk_fma_f32 v[222:223], v[164:165], v[198:199], v[222:223] op_sel:[1,1,0] op_sel_hi:[0,1,1] neg_lo:[1,0,0]
v_pk_fma_f32 v[74:75], v[168:169], v[200:201], v[74:75] op_sel:[1,1,0] op_sel_hi:[0,1,1] neg_lo:[1,0,0]
v_cvt_pk_bf16_f32 v72, v222, v223
v_cvt_pk_bf16_f32 v73, v74, v75
ds_write_b64 v50, v[72:73] offset:1632
v_pk_mul_f32 v[76:77], v[170:171], v[198:199] op_sel:[0,0] op_sel_hi:[1,0]
v_pk_mul_f32 v[78:79], v[172:173], v[200:201] op_sel:[0,0] op_sel_hi:[1,0]
v_pk_fma_f32 v[76:77], v[170:171], v[198:199], v[76:77] op_sel:[1,1,0] op_sel_hi:[0,1,1] neg_lo:[1,0,0]
v_pk_fma_f32 v[78:79], v[172:173], v[200:201], v[78:79] op_sel:[1,1,0] op_sel_hi:[0,1,1] neg_lo:[1,0,0]
v_cvt_pk_bf16_f32 v66, v76, v77
v_cvt_pk_bf16_f32 v67, v78, v79
ds_write_b64 v50, v[66:67] offset:2176
v_pk_mul_f32 v[80:81], v[178:179], v[198:199] op_sel:[0,0] op_sel_hi:[1,0]
v_pk_mul_f32 v[82:83], v[180:181], v[200:201] op_sel:[0,0] op_sel_hi:[1,0]
v_pk_fma_f32 v[80:81], v[178:179], v[198:199], v[80:81] op_sel:[1,1,0] op_sel_hi:[0,1,1] neg_lo:[1,0,0]
v_pk_fma_f32 v[82:83], v[180:181], v[200:201], v[82:83] op_sel:[1,1,0] op_sel_hi:[0,1,1] neg_lo:[1,0,0]
v_cvt_pk_bf16_f32 v68, v80, v81
v_cvt_pk_bf16_f32 v69, v82, v83
ds_write_b64 v50, v[68:69] offset:2720
v_pk_mul_f32 v[84:85], v[186:187], v[198:199] op_sel:[0,0] op_sel_hi:[1,0]
v_pk_mul_f32 v[88:89], v[188:189], v[200:201] op_sel:[0,0] op_sel_hi:[1,0]
v_pk_fma_f32 v[84:85], v[186:187], v[198:199], v[84:85] op_sel:[1,1,0] op_sel_hi:[0,1,1] neg_lo:[1,0,0]
v_pk_fma_f32 v[88:89], v[188:189], v[200:201], v[88:89] op_sel:[1,1,0] op_sel_hi:[0,1,1] neg_lo:[1,0,0]
v_cvt_pk_bf16_f32 v70, v84, v85
v_cvt_pk_bf16_f32 v71, v88, v89
ds_write_b64 v50, v[70:71] offset:3264
v_pk_mul_f32 v[92:93], v[194:195], v[198:199] op_sel:[0,0] op_sel_hi:[1,0]
v_pk_mul_f32 v[96:97], v[196:197], v[200:201] op_sel:[0,0] op_sel_hi:[1,0]
v_pk_fma_f32 v[92:93], v[194:195], v[198:199], v[92:93] op_sel:[1,1,0] op_sel_hi:[0,1,1] neg_lo:[1,0,0]
v_pk_fma_f32 v[96:97], v[196:197], v[200:201], v[96:97] op_sel:[1,1,0] op_sel_hi:[0,1,1] neg_lo:[1,0,0]
v_cvt_pk_bf16_f32 v72, v92, v93
v_cvt_pk_bf16_f32 v73, v96, v97
ds_write_b64 v50, v[72:73] offset:3808
v_pk_mul_f32 v[100:101], v[110:111], v[202:203] op_sel:[0,0] op_sel_hi:[1,0]
v_pk_mul_f32 v[126:127], v[112:113], v[204:205] op_sel:[0,0] op_sel_hi:[1,0]
v_pk_fma_f32 v[100:101], v[110:111], v[202:203], v[100:101] op_sel:[1,1,0] op_sel_hi:[0,1,1] neg_lo:[1,0,0]
v_pk_fma_f32 v[126:127], v[112:113], v[204:205], v[126:127] op_sel:[1,1,0] op_sel_hi:[0,1,1] neg_lo:[1,0,0]
v_cvt_pk_bf16_f32 v66, v100, v101
v_cvt_pk_bf16_f32 v67, v126, v127
ds_write_b64 v50, v[66:67] offset:4352
v_pk_mul_f32 v[166:167], v[164:165], v[202:203] op_sel:[0,0] op_sel_hi:[1,0]
v_pk_mul_f32 v[86:87], v[168:169], v[204:205] op_sel:[0,0] op_sel_hi:[1,0]
v_pk_fma_f32 v[166:167], v[164:165], v[202:203], v[166:167] op_sel:[1,1,0] op_sel_hi:[0,1,1] neg_lo:[1,0,0]
v_pk_fma_f32 v[86:87], v[168:169], v[204:205], v[86:87] op_sel:[1,1,0] op_sel_hi:[0,1,1] neg_lo:[1,0,0]
v_cvt_pk_bf16_f32 v68, v166, v167
v_cvt_pk_bf16_f32 v69, v86, v87
ds_write_b64 v50, v[68:69] offset:4896
v_pk_mul_f32 v[90:91], v[178:179], v[202:203] op_sel:[0,0] op_sel_hi:[1,0]
v_pk_mul_f32 v[174:175], v[180:181], v[204:205] op_sel:[0,0] op_sel_hi:[1,0]
v_pk_fma_f32 v[90:91], v[178:179], v[202:203], v[90:91] op_sel:[1,1,0] op_sel_hi:[0,1,1] neg_lo:[1,0,0]
v_pk_fma_f32 v[174:175], v[180:181], v[204:205], v[174:175] op_sel:[1,1,0] op_sel_hi:[0,1,1] neg_lo:[1,0,0]
v_cvt_pk_bf16_f32 v70, v90, v91
v_cvt_pk_bf16_f32 v71, v174, v175
ds_write_b64 v50, v[70:71] offset:5440
v_pk_mul_f32 v[176:177], v[194:195], v[202:203] op_sel:[0,0] op_sel_hi:[1,0]
v_pk_mul_f32 v[106:107], v[196:197], v[204:205] op_sel:[0,0] op_sel_hi:[1,0]
v_pk_fma_f32 v[176:177], v[194:195], v[202:203], v[176:177] op_sel:[1,1,0] op_sel_hi:[0,1,1] neg_lo:[1,0,0]
v_pk_fma_f32 v[106:107], v[196:197], v[204:205], v[106:107] op_sel:[1,1,0] op_sel_hi:[0,1,1] neg_lo:[1,0,0]
v_cvt_pk_bf16_f32 v72, v176, v177
v_cvt_pk_bf16_f32 v73, v106, v107
ds_write_b64 v50, v[72:73] offset:5984
v_pk_mul_f32 v[108:109], v[214:215], v[202:203] op_sel:[0,0] op_sel_hi:[1,0]
v_pk_mul_f32 v[182:183], v[216:217], v[204:205] op_sel:[0,0] op_sel_hi:[1,0]
v_pk_fma_f32 v[108:109], v[214:215], v[202:203], v[108:109] op_sel:[1,1,0] op_sel_hi:[0,1,1] neg_lo:[1,0,0]
v_pk_fma_f32 v[182:183], v[216:217], v[204:205], v[182:183] op_sel:[1,1,0] op_sel_hi:[0,1,1] neg_lo:[1,0,0]
v_cvt_pk_bf16_f32 v66, v108, v109
v_cvt_pk_bf16_f32 v67, v182, v183
ds_write_b64 v50, v[66:67] offset:6528
v_pk_mul_f32 v[184:185], v[222:223], v[202:203] op_sel:[0,0] op_sel_hi:[1,0]
v_pk_mul_f32 v[114:115], v[74:75], v[204:205] op_sel:[0,0] op_sel_hi:[1,0]
v_pk_fma_f32 v[184:185], v[222:223], v[202:203], v[184:185] op_sel:[1,1,0] op_sel_hi:[0,1,1] neg_lo:[1,0,0]
v_pk_fma_f32 v[114:115], v[74:75], v[204:205], v[114:115] op_sel:[1,1,0] op_sel_hi:[0,1,1] neg_lo:[1,0,0]
v_cvt_pk_bf16_f32 v68, v184, v185
v_cvt_pk_bf16_f32 v69, v114, v115
ds_write_b64 v50, v[68:69] offset:7072
v_pk_mul_f32 v[116:117], v[80:81], v[202:203] op_sel:[0,0] op_sel_hi:[1,0]
v_pk_mul_f32 v[190:191], v[82:83], v[204:205] op_sel:[0,0] op_sel_hi:[1,0]
v_pk_fma_f32 v[116:117], v[80:81], v[202:203], v[116:117] op_sel:[1,1,0] op_sel_hi:[0,1,1] neg_lo:[1,0,0]
v_pk_fma_f32 v[190:191], v[82:83], v[204:205], v[190:191] op_sel:[1,1,0] op_sel_hi:[0,1,1] neg_lo:[1,0,0]
v_cvt_pk_bf16_f32 v70, v116, v117
v_cvt_pk_bf16_f32 v71, v190, v191
ds_write_b64 v50, v[70:71] offset:7616
v_pk_mul_f32 v[192:193], v[92:93], v[202:203] op_sel:[0,0] op_sel_hi:[1,0]
v_pk_mul_f32 v[122:123], v[96:97], v[204:205] op_sel:[0,0] op_sel_hi:[1,0]
v_pk_fma_f32 v[192:193], v[92:93], v[202:203], v[192:193] op_sel:[1,1,0] op_sel_hi:[0,1,1] neg_lo:[1,0,0]
v_pk_fma_f32 v[122:123], v[96:97], v[204:205], v[122:123] op_sel:[1,1,0] op_sel_hi:[0,1,1] neg_lo:[1,0,0]
v_cvt_pk_bf16_f32 v72, v192, v193
v_cvt_pk_bf16_f32 v73, v122, v123
ds_write_b64 v50, v[72:73] offset:8160
ds_read_b128 a[64:67], v49 offset:0
ds_read_b128 a[68:71], v49 offset:64
ds_read_b128 a[72:75], v49 offset:128
ds_read_b128 a[76:79], v49 offset:192
ds_read_b128 a[80:83], v49 offset:256
ds_read_b128 a[84:87], v49 offset:320
ds_read_b128 a[88:91], v49 offset:384
ds_read_b128 a[92:95], v49 offset:448
v_pk_mul_f32 v[124:125], v[164:165], v[206:207] op_sel:[0,0] op_sel_hi:[1,0]
v_pk_mul_f32 v[100:101], v[168:169], v[208:209] op_sel:[0,0] op_sel_hi:[1,0]
v_pk_fma_f32 v[124:125], v[164:165], v[206:207], v[124:125] op_sel:[1,1,0] op_sel_hi:[0,1,1] neg_lo:[1,0,0]
v_pk_fma_f32 v[100:101], v[168:169], v[208:209], v[100:101] op_sel:[1,1,0] op_sel_hi:[0,1,1] neg_lo:[1,0,0]
v_cvt_pk_bf16_f32 v66, v124, v125
v_cvt_pk_bf16_f32 v67, v100, v101
ds_write_b64 v50, v[66:67] offset:0
v_pk_mul_f32 v[126:127], v[194:195], v[206:207] op_sel:[0,0] op_sel_hi:[1,0]
v_pk_mul_f32 v[90:91], v[196:197], v[208:209] op_sel:[0,0] op_sel_hi:[1,0]
v_pk_fma_f32 v[126:127], v[194:195], v[206:207], v[126:127] op_sel:[1,1,0] op_sel_hi:[0,1,1] neg_lo:[1,0,0]
v_pk_fma_f32 v[90:91], v[196:197], v[208:209], v[90:91] op_sel:[1,1,0] op_sel_hi:[0,1,1] neg_lo:[1,0,0]
v_cvt_pk_bf16_f32 v68, v126, v127
v_cvt_pk_bf16_f32 v69, v90, v91
ds_write_b64 v50, v[68:69] offset:544
v_pk_mul_f32 v[174:175], v[222:223], v[206:207] op_sel:[0,0] op_sel_hi:[1,0]
v_pk_mul_f32 v[108:109], v[74:75], v[208:209] op_sel:[0,0] op_sel_hi:[1,0]
v_pk_fma_f32 v[174:175], v[222:223], v[206:207], v[174:175] op_sel:[1,1,0] op_sel_hi:[0,1,1] neg_lo:[1,0,0]
v_pk_fma_f32 v[108:109], v[74:75], v[208:209], v[108:109] op_sel:[1,1,0] op_sel_hi:[0,1,1] neg_lo:[1,0,0]
v_cvt_pk_bf16_f32 v70, v174, v175
v_cvt_pk_bf16_f32 v71, v108, v109
ds_write_b64 v50, v[70:71] offset:1088
v_pk_mul_f32 v[182:183], v[92:93], v[206:207] op_sel:[0,0] op_sel_hi:[1,0]
v_pk_mul_f32 v[116:117], v[96:97], v[208:209] op_sel:[0,0] op_sel_hi:[1,0]
v_pk_fma_f32 v[182:183], v[92:93], v[206:207], v[182:183] op_sel:[1,1,0] op_sel_hi:[0,1,1] neg_lo:[1,0,0]
v_pk_fma_f32 v[116:117], v[96:97], v[208:209], v[116:117] op_sel:[1,1,0] op_sel_hi:[0,1,1] neg_lo:[1,0,0]
v_cvt_pk_bf16_f32 v72, v182, v183
v_cvt_pk_bf16_f32 v73, v116, v117
ds_write_b64 v50, v[72:73] offset:1632
v_pk_mul_f32 v[190:191], v[166:167], v[206:207] op_sel:[0,0] op_sel_hi:[1,0]
v_pk_mul_f32 v[124:125], v[86:87], v[208:209] op_sel:[0,0] op_sel_hi:[1,0]
v_pk_fma_f32 v[190:191], v[166:167], v[206:207], v[190:191] op_sel:[1,1,0] op_sel_hi:[0,1,1] neg_lo:[1,0,0]
v_pk_fma_f32 v[124:125], v[86:87], v[208:209], v[124:125] op_sel:[1,1,0] op_sel_hi:[0,1,1] neg_lo:[1,0,0]
v_cvt_pk_bf16_f32 v66, v190, v191
v_cvt_pk_bf16_f32 v67, v124, v125
ds_write_b64 v50, v[66:67] offset:2176
v_pk_mul_f32 v[100:101], v[176:177], v[206:207] op_sel:[0,0] op_sel_hi:[1,0]
v_pk_mul_f32 v[126:127], v[106:107], v[208:209] op_sel:[0,0] op_sel_hi:[1,0]
v_pk_fma_f32 v[100:101], v[176:177], v[206:207], v[100:101] op_sel:[1,1,0] op_sel_hi:[0,1,1] neg_lo:[1,0,0]
v_pk_fma_f32 v[126:127], v[106:107], v[208:209], v[126:127] op_sel:[1,1,0] op_sel_hi:[0,1,1] neg_lo:[1,0,0]
v_cvt_pk_bf16_f32 v68, v100, v101
v_cvt_pk_bf16_f32 v69, v126, v127
ds_write_b64 v50, v[68:69] offset:2720
v_pk_mul_f32 v[90:91], v[184:185], v[206:207] op_sel:[0,0] op_sel_hi:[1,0]
v_pk_mul_f32 v[174:175], v[114:115], v[208:209] op_sel:[0,0] op_sel_hi:[1,0]
v_pk_fma_f32 v[90:91], v[184:185], v[206:207], v[90:91] op_sel:[1,1,0] op_sel_hi:[0,1,1] neg_lo:[1,0,0]
v_pk_fma_f32 v[174:175], v[114:115], v[208:209], v[174:175] op_sel:[1,1,0] op_sel_hi:[0,1,1] neg_lo:[1,0,0]
v_cvt_pk_bf16_f32 v70, v90, v91
v_cvt_pk_bf16_f32 v71, v174, v175
ds_write_b64 v50, v[70:71] offset:3264
v_pk_mul_f32 v[108:109], v[192:193], v[206:207] op_sel:[0,0] op_sel_hi:[1,0]
v_pk_mul_f32 v[182:183], v[122:123], v[208:209] op_sel:[0,0] op_sel_hi:[1,0]
v_pk_fma_f32 v[108:109], v[192:193], v[206:207], v[108:109] op_sel:[1,1,0] op_sel_hi:[0,1,1] neg_lo:[1,0,0]
v_pk_fma_f32 v[182:183], v[122:123], v[208:209], v[182:183] op_sel:[1,1,0] op_sel_hi:[0,1,1] neg_lo:[1,0,0]
v_cvt_pk_bf16_f32 v72, v108, v109
v_cvt_pk_bf16_f32 v73, v182, v183
ds_write_b64 v50, v[72:73] offset:3808
v_mov_b32 v66, 0x3f80
v_mov_b32 v67, 0x3f80
ds_write_b64 v50, v[66:67] offset:4352
ds_read_b128 a[96:99], v49 offset:0
ds_read_b128 a[100:103], v49 offset:64
ds_read_b128 a[104:107], v49 offset:128
ds_read_b128 a[108:111], v49 offset:192
ds_read_b128 a[112:115], v49 offset:256
ds_read_b128 a[116:119], v49 offset:320
ds_read_b128 a[120:123], v49 offset:384
ds_read_b128 a[124:127], v49 offset:448
v_mov_b32 v66, 0
v_mov_b32 v67, 0
ds_write_b64 v50, v[66:67]
s_waitcnt vmcnt(0)
s_branch Lg1
Lbeta:
s_waitcnt lgkmcnt(0)
s_mov_b64 s[48:49], s[16:17]
s_mov_b64 s[52:53], s[36:37]
s_mov_b64 s[56:57], s[46:47]
s_mov_b64 s[60:61], s[42:43]
s_mov_b64 s[64:65], s[46:47]
s_mov_b64 s[96:97], s[38:39]
s_cmp_lg_u32 s14, 27
s_cbranch_scc1 Lng_3
s_nop 0
global_load_dwordx4 v[144:147], v5, s[40:41]
v_add_u32 v134, 1024, v5
v_min_u32 v134, 0x4f0, v134
global_load_dwordx4 v[148:151], v134, s[40:41]
Lng_3:
s_load_dwordx2 s[68:69], s[46:47], 0
s_barrier
s_cmp_eq_u32 s85, 1
s_cbranch_scc1 Lb_ut
s_cmp_lg_u32 s9, 13
s_cbranch_scc1 Lb_none
s_cmp_ge_u32 s8, 12
s_cbranch_scc1 Lb_none
s_add_u32 s85, s8, 128
v_lshlrev_b32 v6, 1, v3
v_xor_b32_e64 v6, v6, v2
v_mul_u32_u24 v7, 1280, v3
v_lshl_add_u32 v48, v6, 4, v7
v_xor_b32_e64 v6, 8, v6
v_lshl_add_u32 v49, v6, 4, v7
s_mul_i32 s73, s85, 13108
s_lshr_b32 s73, s73, 16
s_mul_i32 s74, s73, 5
s_sub_u32 s74, s85, s74
s_mul_i32 s91, s73, 81920
s_lshl_b32 s75, s74, 8
s_add_u32 s91, s91, s75
s_mov_b32 m0, 135168
s_add_u32 s78, s91, 0
buffer_load_dwordx4 v48, s[96:99], s78 offen nt lds
s_mov_b32 m0, 136192
s_add_u32 s78, s91, 20480
buffer_load_dwordx4 v48, s[96:99], s78 offen nt lds
s_mov_b32 m0, 137216
s_add_u32 s78, s91, 5120
buffer_load_dwordx4 v49, s[96:99], s78 offen nt lds
s_mov_b32 m0, 138240
s_add_u32 s78, s91, 25600
buffer_load_dwordx4 v49, s[96:99], s78 offen nt lds
s_mov_b32 m0, 139264
s_add_u32 s78, s91, 10240
buffer_load_dwordx4 v48, s[96:99], s78 offen nt lds
s_mov_b32 m0, 140288
s_add_u32 s78, s91, 30720
buffer_load_dwordx4 v48, s[96:99], s78 offen nt lds
s_mov_b32 m0, 141312
s_add_u32 s78, s91, 15360
buffer_load_dwordx4 v49, s[96:99], s78 offen nt lds
s_mov_b32 m0, 142336
s_add_u32 s78, s91, 35840
buffer_load_dwordx4 v49, s[96:99], s78 offen nt lds
s_mov_b32 m0, 143360
s_add_u32 s78, s91, 40960
buffer_load_dwordx4 v48, s[96:99], s78 offen nt lds
s_mov_b32 m0, 144384
s_add_u32 s78, s91, 61440
buffer_load_dwordx4 v48, s[96:99], s78 offen nt lds
s_mov_b32 m0, 145408
s_add_u32 s78, s91, 46080
buffer_load_dwordx4 v49, s[96:99], s78 offen nt lds
s_mov_b32 m0, 146432
s_add_u32 s78, s91, 66560
buffer_load_dwordx4 v49, s[96:99], s78 offen nt lds
s_mov_b32 m0, 147456
s_add_u32 s78, s91, 51200
buffer_load_dwordx4 v48, s[96:99], s78 offen nt lds
s_mov_b32 m0, 148480
s_add_u32 s78, s91, 71680
buffer_load_dwordx4 v48, s[96:99], s78 offen nt lds
s_mov_b32 m0, 149504
s_add_u32 s78, s91, 56320
buffer_load_dwordx4 v49, s[96:99], s78 offen nt lds
s_mov_b32 m0, 150528
s_add_u32 s78, s91, 76800
buffer_load_dwordx4 v49, s[96:99], s78 offen nt lds
s_mul_i32 s90, s74, 458752
s_lshl_b32 s75, s73, 11
s_add_u32 s90, s90, s75
s_add_u32 s90, s90, 7340032
s_lshl_b32 s83, s85, 6
s_add_u32 s83, s83, 16384
s_mov_b32 m0, 0
s_sub_u32 s75, s70, 122880
buffer_load_dwordx4 v8, s[48:51], s75 offen offset:0 lds
buffer_load_dwordx4 v9, s[48:51], s75 offen offset:1024 lds
buffer_load_dwordx4 v10, s[48:51], s75 offen offset:2048 lds
buffer_load_dwordx4 v11, s[48:51], s75 offen offset:3072 lds
s_mov_b32 m0, 4096
s_sub_u32 s75, s70, 81920
buffer_load_dwordx4 v8, s[48:51], s75 offen offset:0 lds
buffer_load_dwordx4 v9, s[48:51], s75 offen offset:1024 lds
buffer_load_dwordx4 v10, s[48:51], s75 offen offset:2048 lds
buffer_load_dwordx4 v11, s[48:51], s75 offen offset:3072 lds
s_mov_b32 m0, 8192
s_sub_u32 s75, s70, 40960
buffer_load_dwordx4 v8, s[48:51], s75 offen offset:0 lds
buffer_load_dwordx4 v9, s[48:51], s75 offen offset:1024 lds
buffer_load_dwordx4 v10, s[48:51], s75 offen offset:2048 lds
buffer_load_dwordx4 v11, s[48:51], s75 offen offset:3072 lds
s_mov_b32 m0, 12288
s_sub_u32 s75, s70, 0
s_nop 0
buffer_load_dwordx4 v8, s[48:51], s75 offen offset:0 lds
buffer_load_dwordx4 v9, s[48:51], s75 offen offset:1024 lds
buffer_load_dwordx4 v10, s[48:51], s75 offen offset:2048 lds
buffer_load_dwordx4 v11, s[48:51], s75 offen offset:3072 lds
s_add_u32 m0, s72, 16384
s_nop 0
buffer_load_dwordx4 v12, s[52:55], s71 offen offset:0 lds
buffer_load_dwordx4 v13, s[52:55], s71 offen offset:1024 lds
buffer_load_dwordx4 v14, s[52:55], s71 offen offset:2048 lds
buffer_load_dwordx4 v15, s[52:55], s71 offen offset:3072 lds
s_and_b32 s73, s3, 1
s_lshl_b32 s73, s73, 13
v_lshrrev_b32 v6, 1, v2
v_xor_b32_e64 v6, v6, v3
v_lshl_add_u32 v7, v2, 7, s73
v_lshl_add_u32 v16, v6, 4, v7
v_xor_b32_e64 v17, 64, v16
v_add_u32 v18, 0x10000, v16
v_add_u32 v19, 0x10000, v17
v_lshrrev_b32 v6, 2, v2
v_and_b32 v7, 1, v3
v_lshl_or_b32 v7, v7, 2, v6
v_lshl_add_u32 v6, v3, 3, v6
v_lshlrev_b32_e64 v6, 8, v6
v_lshl_add_u32 v6, v7, 5, v6
v_and_b32_e64 v7, 3, v2
v_lshl_add_u32 v20, v7, 3, v6
s_lshr_b32 s74, s3, 1
s_lshl_b32 s74, s74, 7
v_xor_b32 v20, s74, v20
v_xor_b32 v21, 32, v20
v_xor_b32_e64 v22, 64, v20
v_xor_b32 v23, 96, v20
v_add_u32 v24, 0x10000, v20
v_add_u32 v25, 0x10000, v21
v_add_u32 v26, 0x10000, v22
v_add_u32 v27, 0x10000, v23
s_waitcnt lgkmcnt(0)
s_mul_i32 s68, s68, 0x9e3779b1
s_add_u32 s68, s68, 0x7f4a7c15
s_mul_i32 s69, s69, 0x85ebca6b
s_add_u32 s69, s69, s68
s_or_b32 s69, s69, 1
v_mov_b32 v60, s68
v_mov_b32 v61, s69
v_lshrrev_b32 v6, 2, v2
v_and_b32_e64 v7, 1, v3
v_lshl_or_b32 v7, v7, 2, v6
v_lshl_add_u32 v6, v3, 3, v6
v_lshlrev_b32_e64 v6, 8, v6
v_lshl_add_u32 v6, v7, 5, v6
v_and_b32_e64 v7, 3, v2
v_lshl_add_u32 v50, v7, 3, v6
v_add_u32 v50, 135168, v50
s_waitcnt vmcnt(20)
s_cmp_lg_u32 s14, 27
s_cbranch_scc1 Lng_4
v_add_u32 v6, 160512, v5
v_add_u32 v134, 160512, v134
ds_write_b128 v6, v[144:147]
ds_write_b128 v134, v[148:151]
Lng_4:
v_xor_b32 v6, 0, v50
ds_read_b64_tr_b16 v[64:65], v6 offset:0
ds_read_b64_tr_b16 v[66:67], v6 offset:1024
ds_read_b64_tr_b16 v[68:69], v6 offset:8192
ds_read_b64_tr_b16 v[70:71], v6 offset:9216
v_xor_b32_e64 v6, 32, v50
ds_read_b64_tr_b16 v[72:73], v6 offset:0
ds_read_b64_tr_b16 v[74:75], v6 offset:1024
ds_read_b64_tr_b16 v[76:77], v6 offset:8192
ds_read_b64_tr_b16 v[78:79], v6 offset:9216
v_xor_b32_e64 v6, 64, v50
ds_read_b64_tr_b16 v[80:81], v6 offset:0
ds_read_b64_tr_b16 v[82:83], v6 offset:1024
ds_read_b64_tr_b16 v[84:85], v6 offset:8192
ds_read_b64_tr_b16 v[86:87], v6 offset:9216
v_xor_b32 v6, 96, v50
ds_read_b64_tr_b16 v[88:89], v6 offset:0
ds_read_b64_tr_b16 v[90:91], v6 offset:1024
ds_read_b64_tr_b16 v[92:93], v6 offset:8192
ds_read_b64_tr_b16 v[94:95], v6 offset:9216
v_xor_b32 v6, 128, v50
ds_read_b64_tr_b16 v[96:97], v6 offset:0
ds_read_b64_tr_b16 v[98:99], v6 offset:1024
ds_read_b64_tr_b16 v[100:101], v6 offset:8192
ds_read_b64_tr_b16 v[102:103], v6 offset:9216
v_xor_b32 v6, 160, v50
ds_read_b64_tr_b16 v[104:105], v6 offset:0
ds_read_b64_tr_b16 v[106:107], v6 offset:1024
ds_read_b64_tr_b16 v[108:109], v6 offset:8192
ds_read_b64_tr_b16 v[110:111], v6 offset:9216
v_xor_b32 v6, 192, v50
ds_read_b64_tr_b16 v[112:113], v6 offset:0
ds_read_b64_tr_b16 v[114:115], v6 offset:1024
ds_read_b64_tr_b16 v[116:117], v6 offset:8192
ds_read_b64_tr_b16 v[118:119], v6 offset:9216
v_xor_b32 v6, 224, v50
ds_read_b64_tr_b16 v[120:121], v6 offset:0
ds_read_b64_tr_b16 v[122:123], v6 offset:1024
ds_read_b64_tr_b16 v[124:125], v6 offset:8192
ds_read_b64_tr_b16 v[126:127], v6 offset:9216
s_add_u32 s76, s90, 0
s_waitcnt lgkmcnt(15)
buffer_store_dwordx4 v[64:67], v5, s[56:59], s76 offen offset:0 sc1
buffer_store_dwordx4 v[68:71], v5, s[56:59], s76 offen offset:1024 sc1
s_add_u32 s76, s90, 57344
buffer_store_dwordx4 v[72:75], v5, s[56:59], s76 offen offset:0 sc1
buffer_store_dwordx4 v[76:79], v5, s[56:59], s76 offen offset:1024 sc1
s_add_u32 s76, s90, 114688
buffer_store_dwordx4 v[80:83], v5, s[56:59], s76 offen offset:0 sc1
buffer_store_dwordx4 v[84:87], v5, s[56:59], s76 offen offset:1024 sc1
s_add_u32 s76, s90, 172032
buffer_store_dwordx4 v[88:91], v5, s[56:59], s76 offen offset:0 sc1
buffer_store_dwordx4 v[92:95], v5, s[56:59], s76 offen offset:1024 sc1
s_add_u32 s76, s90, 229376
s_waitcnt lgkmcnt(14)
buffer_store_dwordx4 v[96:99], v5, s[56:59], s76 offen offset:0 sc1
s_waitcnt lgkmcnt(12)
buffer_store_dwordx4 v[100:103], v5, s[56:59], s76 offen offset:1024 sc1
s_add_u32 s76, s90, 286720
s_waitcnt lgkmcnt(10)
buffer_store_dwordx4 v[104:107], v5, s[56:59], s76 offen offset:0 sc1
s_waitcnt lgkmcnt(8)
buffer_store_dwordx4 v[108:111], v5, s[56:59], s76 offen offset:1024 sc1
s_add_u32 s76, s90, 344064
s_waitcnt lgkmcnt(6)
buffer_store_dwordx4 v[112:115], v5, s[56:59], s76 offen offset:0 sc1
s_waitcnt lgkmcnt(4)
buffer_store_dwordx4 v[116:119], v5, s[56:59], s76 offen offset:1024 sc1
s_add_u32 s76, s90, 401408
s_waitcnt lgkmcnt(2)
buffer_store_dwordx4 v[120:123], v5, s[56:59], s76 offen offset:0 sc1
s_waitcnt lgkmcnt(0)
buffer_store_dwordx4 v[124:127], v5, s[56:59], s76 offen offset:1024 sc1
s_add_u32 s12, s12, 1
s_cmp_eq_u32 s12, 10
s_cselect_b32 s78, 9, -1
s_mul_i32 s79, s78, 128
s_sub_u32 s70, s70, s79
s_mul_i32 s79, s78, 221184
s_sub_u32 s71, s71, s79
s_cmp_eq_u32 s12, 10
s_cselect_b32 s12, 0, s12
s_nop 0
s_mov_b32 m0, 32768
s_sub_u32 s75, s70, 122880
buffer_load_dwordx4 v8, s[48:51], s75 offen offset:0 lds
buffer_load_dwordx4 v9, s[48:51], s75 offen offset:1024 lds
buffer_load_dwordx4 v10, s[48:51], s75 offen offset:2048 lds
buffer_load_dwordx4 v11, s[48:51], s75 offen offset:3072 lds
s_mov_b32 m0, 49152
s_sub_u32 s75, s71, 165888
buffer_load_dwordx4 v12, s[52:55], s75 offen offset:0 lds
buffer_load_dwordx4 v13, s[52:55], s75 offen offset:1024 lds
buffer_load_dwordx4 v14, s[52:55], s75 offen offset:2048 lds
buffer_load_dwordx4 v15, s[52:55], s75 offen offset:3072 lds
s_mov_b32 m0, 36864
s_sub_u32 s75, s70, 81920
buffer_load_dwordx4 v8, s[48:51], s75 offen offset:0 lds
buffer_load_dwordx4 v9, s[48:51], s75 offen offset:1024 lds
buffer_load_dwordx4 v10, s[48:51], s75 offen offset:2048 lds
buffer_load_dwordx4 v11, s[48:51], s75 offen offset:3072 lds
s_mov_b32 m0, 53248
s_sub_u32 s75, s71, 110592
buffer_load_dwordx4 v12, s[52:55], s75 offen offset:0 lds
buffer_load_dwordx4 v13, s[52:55], s75 offen offset:1024 lds
buffer_load_dwordx4 v14, s[52:55], s75 offen offset:2048 lds
buffer_load_dwordx4 v15, s[52:55], s75 offen offset:3072 lds
s_mov_b32 m0, 40960
s_sub_u32 s75, s70, 40960
buffer_load_dwordx4 v8, s[48:51], s75 offen offset:0 lds
buffer_load_dwordx4 v9, s[48:51], s75 offen offset:1024 lds
buffer_load_dwordx4 v10, s[48:51], s75 offen offset:2048 lds
buffer_load_dwordx4 v11, s[48:51], s75 offen offset:3072 lds
s_mov_b32 m0, 57344
s_sub_u32 s75, s71, 55296
buffer_load_dwordx4 v12, s[52:55], s75 offen offset:0 lds
buffer_load_dwordx4 v13, s[52:55], s75 offen offset:1024 lds
buffer_load_dwordx4 v14, s[52:55], s75 offen offset:2048 lds
buffer_load_dwordx4 v15, s[52:55], s75 offen offset:3072 lds
s_mov_b32 m0, 45056
s_sub_u32 s75, s70, 0
s_nop 0
buffer_load_dwordx4 v8, s[48:51], s75 offen offset:0 lds
buffer_load_dwordx4 v9, s[48:51], s75 offen offset:1024 lds
buffer_load_dwordx4 v10, s[48:51], s75 offen offset:2048 lds
buffer_load_dwordx4 v11, s[48:51], s75 offen offset:3072 lds
s_mov_b32 m0, 61440
s_sub_u32 s75, s71, 0
buffer_load_dwordx4 v12, s[52:55], s75 offen offset:0 lds
buffer_load_dwordx4 v13, s[52:55], s75 offen offset:1024 lds
buffer_load_dwordx4 v14, s[52:55], s75 offen offset:2048 lds
buffer_load_dwordx4 v15, s[52:55], s75 offen offset:3072 lds
s_add_u32 s12, s12, 1
s_cmp_eq_u32 s12, 10
s_cselect_b32 s78, 9, -1
s_mul_i32 s79, s78, 128
s_sub_u32 s70, s70, s79
s_mul_i32 s79, s78, 221184
s_sub_u32 s71, s71, s79
s_cmp_eq_u32 s12, 10
s_cselect_b32 s12, 0, s12
s_mov_b32 m0, 65536
s_sub_u32 s75, s70, 122880
buffer_load_dwordx4 v8, s[48:51], s75 offen offset:0 lds
buffer_load_dwordx4 v9, s[48:51], s75 offen offset:1024 lds
buffer_load_dwordx4 v10, s[48:51], s75 offen offset:2048 lds
buffer_load_dwordx4 v11, s[48:51], s75 offen offset:3072 lds
s_mov_b32 m0, 69632
s_sub_u32 s75, s70, 81920
buffer_load_dwordx4 v8, s[48:51], s75 offen offset:0 lds
buffer_load_dwordx4 v9, s[48:51], s75 offen offset:1024 lds
buffer_load_dwordx4 v10, s[48:51], s75 offen offset:2048 lds
buffer_load_dwordx4 v11, s[48:51], s75 offen offset:3072 lds
s_mov_b32 m0, 73728
s_sub_u32 s75, s70, 40960
buffer_load_dwordx4 v8, s[48:51], s75 offen offset:0 lds
buffer_load_dwordx4 v9, s[48:51], s75 offen offset:1024 lds
buffer_load_dwordx4 v10, s[48:51], s75 offen offset:2048 lds
buffer_load_dwordx4 v11, s[48:51], s75 offen offset:3072 lds
s_mov_b32 m0, 77824
s_sub_u32 s75, s70, 0
buffer_load_dwordx4 v8, s[48:51], s75 offen offset:0 lds
buffer_load_dwordx4 v9, s[48:51], s75 offen offset:1024 lds
buffer_load_dwordx4 v10, s[48:51], s75 offen offset:2048 lds
buffer_load_dwordx4 v11, s[48:51], s75 offen offset:3072 lds
s_waitcnt vmcnt(48)
s_mov_b64 exec, 1
buffer_store_dwordx2 v[60:61], off, s[56:59], s83 sc1
s_mov_b64 exec, -1
s_mov_b64 exec, 1
s_nop 0
buffer_store_dword v5, off, s[64:67], 0
buffer_store_dword v5, off, s[64:67], 0
buffer_store_dword v5, off, s[64:67], 0
buffer_store_dword v5, off, s[64:67], 0
buffer_store_dword v5, off, s[64:67], 0
buffer_store_dword v5, off, s[64:67], 0
buffer_store_dword v5, off, s[64:67], 0
buffer_store_dword v5, off, s[64:67], 0
buffer_store_dword v5, off, s[64:67], 0
buffer_store_dword v5, off, s[64:67], 0
buffer_store_dword v5, off, s[64:67], 0
buffer_store_dword v5, off, s[64:67], 0
buffer_store_dword v5, off, s[64:67], 0
buffer_store_dword v5, off, s[64:67], 0
buffer_store_dword v5, off, s[64:67], 0
buffer_store_dword v5, off, s[64:67], 0
s_mov_b64 exec, -1
s_branch Lb_done
Lb_none:
s_mov_b32 m0, 0
s_nop 0
s_sub_u32 s75, s70, 122880
buffer_load_dwordx4 v8, s[48:51], s75 offen offset:0 lds
buffer_load_dwordx4 v9, s[48:51], s75 offen offset:1024 lds
buffer_load_dwordx4 v10, s[48:51], s75 offen offset:2048 lds
buffer_load_dwordx4 v11, s[48:51], s75 offen offset:3072 lds
s_mov_b32 m0, 4096
s_sub_u32 s75, s70, 81920
buffer_load_dwordx4 v8, s[48:51], s75 offen offset:0 lds
buffer_load_dwordx4 v9, s[48:51], s75 offen offset:1024 lds
buffer_load_dwordx4 v10, s[48:51], s75 offen offset:2048 lds
buffer_load_dwordx4 v11, s[48:51], s75 offen offset:3072 lds
s_mov_b32 m0, 8192
s_sub_u32 s75, s70, 40960
buffer_load_dwordx4 v8, s[48:51], s75 offen offset:0 lds
buffer_load_dwordx4 v9, s[48:51], s75 offen offset:1024 lds
buffer_load_dwordx4 v10, s[48:51], s75 offen offset:2048 lds
buffer_load_dwordx4 v11, s[48:51], s75 offen offset:3072 lds
s_mov_b32 m0, 12288
s_sub_u32 s75, s70, 0
s_nop 0
buffer_load_dwordx4 v8, s[48:51], s75 offen offset:0 lds
buffer_load_dwordx4 v9, s[48:51], s75 offen offset:1024 lds
buffer_load_dwordx4 v10, s[48:51], s75 offen offset:2048 lds
buffer_load_dwordx4 v11, s[48:51], s75 offen offset:3072 lds
s_add_u32 m0, s72, 16384
s_nop 0
buffer_load_dwordx4 v12, s[52:55], s71 offen offset:0 lds
buffer_load_dwordx4 v13, s[52:55], s71 offen offset:1024 lds
buffer_load_dwordx4 v14, s[52:55], s71 offen offset:2048 lds
buffer_load_dwordx4 v15, s[52:55], s71 offen offset:3072 lds
s_add_u32 s12, s12, 1
s_cmp_eq_u32 s12, 10
s_cselect_b32 s78, 9, -1
s_mul_i32 s79, s78, 128
s_sub_u32 s70, s70, s79
s_mul_i32 s79, s78, 221184
s_sub_u32 s71, s71, s79
s_cmp_eq_u32 s12, 10
s_cselect_b32 s12, 0, s12
s_mov_b32 m0, 32768
s_sub_u32 s75, s70, 122880
buffer_load_dwordx4 v8, s[48:51], s75 offen offset:0 lds
buffer_load_dwordx4 v9, s[48:51], s75 offen offset:1024 lds
buffer_load_dwordx4 v10, s[48:51], s75 offen offset:2048 lds
buffer_load_dwordx4 v11, s[48:51], s75 offen offset:3072 lds
s_mov_b32 m0, 49152
s_sub_u32 s75, s71, 165888
buffer_load_dwordx4 v12, s[52:55], s75 offen offset:0 lds
buffer_load_dwordx4 v13, s[52:55], s75 offen offset:1024 lds
buffer_load_dwordx4 v14, s[52:55], s75 offen offset:2048 lds
buffer_load_dwordx4 v15, s[52:55], s75 offen offset:3072 lds
s_mov_b32 m0, 36864
s_sub_u32 s75, s70, 81920
buffer_load_dwordx4 v8, s[48:51], s75 offen offset:0 lds
buffer_load_dwordx4 v9, s[48:51], s75 offen offset:1024 lds
buffer_load_dwordx4 v10, s[48:51], s75 offen offset:2048 lds
buffer_load_dwordx4 v11, s[48:51], s75 offen offset:3072 lds
s_mov_b32 m0, 53248
s_sub_u32 s75, s71, 110592
buffer_load_dwordx4 v12, s[52:55], s75 offen offset:0 lds
buffer_load_dwordx4 v13, s[52:55], s75 offen offset:1024 lds
buffer_load_dwordx4 v14, s[52:55], s75 offen offset:2048 lds
buffer_load_dwordx4 v15, s[52:55], s75 offen offset:3072 lds
s_and_b32 s73, s3, 1
s_lshl_b32 s73, s73, 13
v_lshrrev_b32 v6, 1, v2
v_xor_b32 v6, v6, v3
v_lshl_add_u32 v7, v2, 7, s73
v_lshl_add_u32 v16, v6, 4, v7
v_xor_b32_e64 v17, 64, v16
v_add_u32 v18, 0x10000, v16
v_add_u32 v19, 0x10000, v17
v_lshrrev_b32 v6, 2, v2
v_and_b32 v7, 1, v3
v_lshl_or_b32 v7, v7, 2, v6
v_lshl_add_u32 v6, v3, 3, v6
v_lshlrev_b32_e64 v6, 8, v6
v_lshl_add_u32 v6, v7, 5, v6
v_and_b32_e64 v7, 3, v2
v_lshl_add_u32 v20, v7, 3, v6
s_lshr_b32 s74, s3, 1
s_lshl_b32 s74, s74, 7
v_xor_b32 v20, s74, v20
v_xor_b32 v21, 32, v20
v_xor_b32_e64 v22, 64, v20
v_xor_b32 v23, 96, v20
v_add_u32 v24, 0x10000, v20
v_add_u32 v25, 0x10000, v21
v_add_u32 v26, 0x10000, v22
v_add_u32 v27, 0x10000, v23
s_waitcnt lgkmcnt(0)
s_mul_i32 s68, s68, 0x9e3779b1
s_add_u32 s68, s68, 0x7f4a7c15
s_mul_i32 s69, s69, 0x85ebca6b
s_add_u32 s69, s69, s68
s_or_b32 s69, s69, 1
v_mov_b32 v60, s68
v_mov_b32 v61, s69
s_waitcnt vmcnt(20)
s_cmp_lg_u32 s14, 27
s_cbranch_scc1 Lng_5
v_add_u32 v6, 160512, v5
v_add_u32 v134, 160512, v134
ds_write_b128 v6, v[144:147]
ds_write_b128 v134, v[148:151]
Lng_5:
s_mov_b32 m0, 40960
s_sub_u32 s75, s70, 40960
buffer_load_dwordx4 v8, s[48:51], s75 offen offset:0 lds
buffer_load_dwordx4 v9, s[48:51], s75 offen offset:1024 lds
buffer_load_dwordx4 v10, s[48:51], s75 offen offset:2048 lds
buffer_load_dwordx4 v11, s[48:51], s75 offen offset:3072 lds
s_mov_b32 m0, 57344
s_sub_u32 s75, s71, 55296
buffer_load_dwordx4 v12, s[52:55], s75 offen offset:0 lds
buffer_load_dwordx4 v13, s[52:55], s75 offen offset:1024 lds
buffer_load_dwordx4 v14, s[52:55], s75 offen offset:2048 lds
buffer_load_dwordx4 v15, s[52:55], s75 offen offset:3072 lds
s_mov_b32 m0, 45056
s_sub_u32 s75, s70, 0
s_nop 0
buffer_load_dwordx4 v8, s[48:51], s75 offen offset:0 lds
buffer_load_dwordx4 v9, s[48:51], s75 offen offset:1024 lds
buffer_load_dwordx4 v10, s[48:51], s75 offen offset:2048 lds
buffer_load_dwordx4 v11, s[48:51], s75 offen offset:3072 lds
s_mov_b32 m0, 61440
s_sub_u32 s75, s71, 0
buffer_load_dwordx4 v12, s[52:55], s75 offen offset:0 lds
buffer_load_dwordx4 v13, s[52:55], s75 offen offset:1024 lds
buffer_load_dwordx4 v14, s[52:55], s75 offen offset:2048 lds
buffer_load_dwordx4 v15, s[52:55], s75 offen offset:3072 lds
s_add_u32 s12, s12, 1
s_cmp_eq_u32 s12, 10
s_cselect_b32 s78, 9, -1
s_mul_i32 s79, s78, 128
s_sub_u32 s70, s70, s79
s_mul_i32 s79, s78, 221184
s_sub_u32 s71, s71, s79
s_cmp_eq_u32 s12, 10
s_cselect_b32 s12, 0, s12
s_mov_b32 m0, 65536
s_sub_u32 s75, s70, 122880
buffer_load_dwordx4 v8, s[48:51], s75 offen offset:0 lds
buffer_load_dwordx4 v9, s[48:51], s75 offen offset:1024 lds
buffer_load_dwordx4 v10, s[48:51], s75 offen offset:2048 lds
buffer_load_dwordx4 v11, s[48:51], s75 offen offset:3072 lds
s_mov_b32 m0, 69632
s_sub_u32 s75, s70, 81920
buffer_load_dwordx4 v8, s[48:51], s75 offen offset:0 lds
buffer_load_dwordx4 v9, s[48:51], s75 offen offset:1024 lds
buffer_load_dwordx4 v10, s[48:51], s75 offen offset:2048 lds
buffer_load_dwordx4 v11, s[48:51], s75 offen offset:3072 lds
s_mov_b32 m0, 73728
s_sub_u32 s75, s70, 40960
buffer_load_dwordx4 v8, s[48:51], s75 offen offset:0 lds
buffer_load_dwordx4 v9, s[48:51], s75 offen offset:1024 lds
buffer_load_dwordx4 v10, s[48:51], s75 offen offset:2048 lds
buffer_load_dwordx4 v11, s[48:51], s75 offen offset:3072 lds
s_mov_b32 m0, 77824
s_sub_u32 s75, s70, 0
buffer_load_dwordx4 v8, s[48:51], s75 offen offset:0 lds
buffer_load_dwordx4 v9, s[48:51], s75 offen offset:1024 lds
buffer_load_dwordx4 v10, s[48:51], s75 offen offset:2048 lds
buffer_load_dwordx4 v11, s[48:51], s75 offen offset:3072 lds
s_mov_b64 exec, 1
buffer_store_dword v5, off, s[64:67], 0
buffer_store_dword v5, off, s[64:67], 0
buffer_store_dword v5, off, s[64:67], 0
buffer_store_dword v5, off, s[64:67], 0
buffer_store_dword v5, off, s[64:67], 0
buffer_store_dword v5, off, s[64:67], 0
buffer_store_dword v5, off, s[64:67], 0
buffer_store_dword v5, off, s[64:67], 0
buffer_store_dword v5, off, s[64:67], 0
buffer_store_dword v5, off, s[64:67], 0
buffer_store_dword v5, off, s[64:67], 0
buffer_store_dword v5, off, s[64:67], 0
buffer_store_dword v5, off, s[64:67], 0
buffer_store_dword v5, off, s[64:67], 0
buffer_store_dword v5, off, s[64:67], 0
buffer_store_dword v5, off, s[64:67], 0
s_mov_b64 exec, -1
s_branch Lb_done
Lb_ut:
s_mov_b32 m0, 0
s_nop 0
s_sub_u32 s75, s70, 122880
buffer_load_dwordx4 v8, s[48:51], s75 offen offset:0 lds
buffer_load_dwordx4 v9, s[48:51], s75 offen offset:1024 lds
buffer_load_dwordx4 v10, s[48:51], s75 offen offset:2048 lds
buffer_load_dwordx4 v11, s[48:51], s75 offen offset:3072 lds
s_mov_b32 m0, 4096
s_sub_u32 s75, s70, 81920
buffer_load_dwordx4 v8, s[48:51], s75 offen offset:0 lds
buffer_load_dwordx4 v9, s[48:51], s75 offen offset:1024 lds
buffer_load_dwordx4 v10, s[48:51], s75 offen offset:2048 lds
buffer_load_dwordx4 v11, s[48:51], s75 offen offset:3072 lds
s_mov_b32 m0, 8192
s_sub_u32 s75, s70, 40960
buffer_load_dwordx4 v8, s[48:51], s75 offen offset:0 lds
buffer_load_dwordx4 v9, s[48:51], s75 offen offset:1024 lds
buffer_load_dwordx4 v10, s[48:51], s75 offen offset:2048 lds
buffer_load_dwordx4 v11, s[48:51], s75 offen offset:3072 lds
s_mov_b32 m0, 12288
s_sub_u32 s75, s70, 0
s_nop 0
buffer_load_dwordx4 v8, s[48:51], s75 offen offset:0 lds
buffer_load_dwordx4 v9, s[48:51], s75 offen offset:1024 lds
buffer_load_dwordx4 v10, s[48:51], s75 offen offset:2048 lds
buffer_load_dwordx4 v11, s[48:51], s75 offen offset:3072 lds
s_add_u32 m0, s72, 16384
s_nop 0
buffer_load_dwordx4 v12, s[52:55], s71 offen offset:0 lds
buffer_load_dwordx4 v13, s[52:55], s71 offen offset:1024 lds
buffer_load_dwordx4 v14, s[52:55], s71 offen offset:2048 lds
buffer_load_dwordx4 v15, s[52:55], s71 offen offset:3072 lds
s_add_u32 s12, s12, 1
s_cmp_eq_u32 s12, 10
s_cselect_b32 s78, 9, -1
s_mul_i32 s79, s78, 128
s_sub_u32 s70, s70, s79
s_mul_i32 s79, s78, 221184
s_sub_u32 s71, s71, s79
s_cmp_eq_u32 s12, 10
s_cselect_b32 s12, 0, s12
s_mov_b32 m0, 32768
s_sub_u32 s75, s70, 122880
buffer_load_dwordx4 v8, s[48:51], s75 offen offset:0 lds
buffer_load_dwordx4 v9, s[48:51], s75 offen offset:1024 lds
buffer_load_dwordx4 v10, s[48:51], s75 offen offset:2048 lds
buffer_load_dwordx4 v11, s[48:51], s75 offen offset:3072 lds
s_mov_b32 m0, 49152
s_sub_u32 s75, s71, 165888
buffer_load_dwordx4 v12, s[52:55], s75 offen offset:0 lds
buffer_load_dwordx4 v13, s[52:55], s75 offen offset:1024 lds
buffer_load_dwordx4 v14, s[52:55], s75 offen offset:2048 lds
buffer_load_dwordx4 v15, s[52:55], s75 offen offset:3072 lds
s_mov_b32 m0, 36864
s_sub_u32 s75, s70, 81920
buffer_load_dwordx4 v8, s[48:51], s75 offen offset:0 lds
buffer_load_dwordx4 v9, s[48:51], s75 offen offset:1024 lds
buffer_load_dwordx4 v10, s[48:51], s75 offen offset:2048 lds
buffer_load_dwordx4 v11, s[48:51], s75 offen offset:3072 lds
s_mov_b32 m0, 53248
s_sub_u32 s75, s71, 110592
buffer_load_dwordx4 v12, s[52:55], s75 offen offset:0 lds
buffer_load_dwordx4 v13, s[52:55], s75 offen offset:1024 lds
buffer_load_dwordx4 v14, s[52:55], s75 offen offset:2048 lds
buffer_load_dwordx4 v15, s[52:55], s75 offen offset:3072 lds
s_and_b32 s73, s3, 1
s_lshl_b32 s73, s73, 13
v_lshrrev_b32 v6, 1, v2
v_xor_b32 v6, v6, v3
v_lshl_add_u32 v7, v2, 7, s73
v_lshl_add_u32 v16, v6, 4, v7
v_xor_b32_e64 v17, 64, v16
v_add_u32 v18, 0x10000, v16
v_add_u32 v19, 0x10000, v17
v_lshrrev_b32 v6, 2, v2
v_and_b32 v7, 1, v3
v_lshl_or_b32 v7, v7, 2, v6
v_lshl_add_u32 v6, v3, 3, v6
v_lshlrev_b32_e64 v6, 8, v6
v_lshl_add_u32 v6, v7, 5, v6
v_and_b32_e64 v7, 3, v2
v_lshl_add_u32 v20, v7, 3, v6
s_lshr_b32 s74, s3, 1
s_lshl_b32 s74, s74, 7
v_xor_b32 v20, s74, v20
v_xor_b32 v21, 32, v20
v_xor_b32_e64 v22, 64, v20
v_xor_b32 v23, 96, v20
v_add_u32 v24, 0x10000, v20
v_add_u32 v25, 0x10000, v21
v_add_u32 v26, 0x10000, v22
v_add_u32 v27, 0x10000, v23
s_waitcnt lgkmcnt(0)
s_mul_i32 s68, s68, 0x9e3779b1
s_add_u32 s68, s68, 0x7f4a7c15
s_mul_i32 s69, s69, 0x85ebca6b
s_add_u32 s69, s69, s68
s_or_b32 s69, s69, 1
v_mov_b32 v60, s68
v_mov_b32 v61, s69
v_lshrrev_b32 v6, 2, v2
v_lshl_add_u32 v7, v3, 3, v6
v_lshlrev_b32 v48, 7, v7
v_lshrrev_b32 v6, 3, v2
v_bfe_u32 v7, v2, 1, 1
v_xor_b32 v6, v6, v7
v_and_b32 v7, 1, v3
v_lshl_or_b32 v6, v7, 2, v6
v_lshl_add_u32 v48, v6, 4, v48
v_and_b32_e64 v7, 1, v2
v_lshl_add_u32 v48, v7, 3, v48
v_xor_b32 v49, 32, v48
v_xor_b32 v50, 64, v48
v_xor_b32 v51, 96, v48
v_mul_u32_u24 v6, 272, v2
v_lshl_add_u32 v6, v3, 4, v6
v_add_u32 v52, 151552, v6
v_mul_u32_u24 v6, 272, v3
v_lshl_add_u32 v6, v2, 4, v6
v_add_u32 v53, 151552, v6
v_mul_u32_u24 v6, 4352, v3
v_lshl_add_u32 v54, v2, 4, v6
s_mul_i32 s90, s13, 278528
s_lshl_b32 s73, s8, 8
s_add_u32 s90, s90, s73
s_add_u32 s90, s90, 1048576
s_lshl4_add_u32 s83, s13, s8
s_lshl_b32 s83, s83, 6
s_add_u32 s83, s83, 4096
s_mov_b32 s66, 20447232
s_waitcnt vmcnt(20)
s_nop 0
ds_read_b64_tr_b16 v[64:65], v48 offset:0
ds_read_b64_tr_b16 v[66:67], v49 offset:512
ds_read_b64_tr_b16 v[68:69], v48 offset:4096
ds_read_b64_tr_b16 v[70:71], v49 offset:4608
ds_read_b64_tr_b16 v[72:73], v48 offset:8192
ds_read_b64_tr_b16 v[74:75], v49 offset:8704
ds_read_b64_tr_b16 v[76:77], v48 offset:12288
ds_read_b64_tr_b16 v[78:79], v49 offset:12800
s_mov_b32 m0, 40960
s_sub_u32 s75, s70, 40960
buffer_load_dwordx4 v8, s[48:51], s75 offen offset:0 lds
buffer_load_dwordx4 v9, s[48:51], s75 offen offset:1024 lds
buffer_load_dwordx4 v10, s[48:51], s75 offen offset:2048 lds
buffer_load_dwordx4 v11, s[48:51], s75 offen offset:3072 lds
ds_read_b64_tr_b16 v[80:81], v49 offset:0
ds_read_b64_tr_b16 v[82:83], v48 offset:512
ds_read_b64_tr_b16 v[84:85], v49 offset:4096
ds_read_b64_tr_b16 v[86:87], v48 offset:4608
ds_read_b64_tr_b16 v[88:89], v49 offset:8192
ds_read_b64_tr_b16 v[90:91], v48 offset:8704
ds_read_b64_tr_b16 v[92:93], v49 offset:12288
ds_read_b64_tr_b16 v[94:95], v48 offset:12800
s_mov_b32 m0, 57344
s_sub_u32 s75, s71, 55296
buffer_load_dwordx4 v12, s[52:55], s75 offen offset:0 lds
buffer_load_dwordx4 v13, s[52:55], s75 offen offset:1024 lds
buffer_load_dwordx4 v14, s[52:55], s75 offen offset:2048 lds
buffer_load_dwordx4 v15, s[52:55], s75 offen offset:3072 lds
ds_read_b64_tr_b16 v[96:97], v50 offset:0
ds_read_b64_tr_b16 v[98:99], v51 offset:512
ds_read_b64_tr_b16 v[100:101], v50 offset:4096
ds_read_b64_tr_b16 v[102:103], v51 offset:4608
ds_read_b64_tr_b16 v[104:105], v50 offset:8192
ds_read_b64_tr_b16 v[106:107], v51 offset:8704
ds_read_b64_tr_b16 v[108:109], v50 offset:12288
ds_read_b64_tr_b16 v[110:111], v51 offset:12800
s_mov_b32 m0, 45056
s_sub_u32 s75, s70, 0
s_nop 0
buffer_load_dwordx4 v8, s[48:51], s75 offen offset:0 lds
buffer_load_dwordx4 v9, s[48:51], s75 offen offset:1024 lds
buffer_load_dwordx4 v10, s[48:51], s75 offen offset:2048 lds
buffer_load_dwordx4 v11, s[48:51], s75 offen offset:3072 lds
ds_read_b64_tr_b16 v[112:113], v51 offset:0
ds_read_b64_tr_b16 v[114:115], v50 offset:512
ds_read_b64_tr_b16 v[116:117], v51 offset:4096
ds_read_b64_tr_b16 v[118:119], v50 offset:4608
ds_read_b64_tr_b16 v[120:121], v51 offset:8192
ds_read_b64_tr_b16 v[122:123], v50 offset:8704
ds_read_b64_tr_b16 v[124:125], v51 offset:12288
ds_read_b64_tr_b16 v[126:127], v50 offset:12800
s_mov_b32 m0, 61440
s_sub_u32 s75, s71, 0
buffer_load_dwordx4 v12, s[52:55], s75 offen offset:0 lds
buffer_load_dwordx4 v13, s[52:55], s75 offen offset:1024 lds
buffer_load_dwordx4 v14, s[52:55], s75 offen offset:2048 lds
buffer_load_dwordx4 v15, s[52:55], s75 offen offset:3072 lds
s_waitcnt lgkmcnt(15)
ds_write_b128 v52, v[64:67] offset:0
s_add_u32 s12, s12, 1
s_cmp_eq_u32 s12, 10
s_cselect_b32 s78, 9, -1
ds_write_b128 v52, v[68:71] offset:64
s_mul_i32 s79, s78, 128
s_sub_u32 s70, s70, s79
ds_write_b128 v52, v[72:75] offset:128
s_mul_i32 s79, s78, 221184
s_sub_u32 s71, s71, s79
ds_write_b128 v52, v[76:79] offset:192
s_cmp_eq_u32 s12, 10
s_cselect_b32 s12, 0, s12
s_nop 0
ds_read_b128 v[160:163], v53 offset:0
ds_read_b128 v[164:167], v53 offset:1088
ds_read_b128 v[168:171], v53 offset:2176
ds_read_b128 v[172:175], v53 offset:3264
ds_write_b128 v52, v[80:83] offset:4352
s_mov_b32 m0, 65536
s_sub_u32 s75, s70, 122880
buffer_load_dwordx4 v8, s[48:51], s75 offen offset:0 lds
ds_write_b128 v52, v[84:87] offset:4416
buffer_load_dwordx4 v9, s[48:51], s75 offen offset:1024 lds
ds_write_b128 v52, v[88:91] offset:4480
buffer_load_dwordx4 v10, s[48:51], s75 offen offset:2048 lds
ds_write_b128 v52, v[92:95] offset:4544
buffer_load_dwordx4 v11, s[48:51], s75 offen offset:3072 lds
ds_read_b128 v[176:179], v53 offset:4352
ds_read_b128 v[180:183], v53 offset:5440
ds_read_b128 v[184:187], v53 offset:6528
ds_read_b128 v[188:191], v53 offset:7616
s_waitcnt lgkmcnt(15)
s_nop 0
ds_write_b128 v52, v[96:99] offset:0
s_mov_b32 m0, 69632
s_sub_u32 s75, s70, 81920
buffer_load_dwordx4 v8, s[48:51], s75 offen offset:0 lds
ds_write_b128 v52, v[100:103] offset:64
buffer_load_dwordx4 v9, s[48:51], s75 offen offset:1024 lds
ds_write_b128 v52, v[104:107] offset:128
buffer_load_dwordx4 v10, s[48:51], s75 offen offset:2048 lds
ds_write_b128 v52, v[108:111] offset:192
buffer_load_dwordx4 v11, s[48:51], s75 offen offset:3072 lds
ds_read_b128 v[192:195], v53 offset:0
ds_read_b128 v[196:199], v53 offset:1088
ds_read_b128 v[200:203], v53 offset:2176
ds_read_b128 v[204:207], v53 offset:3264
ds_write_b128 v52, v[112:115] offset:4352
s_mov_b32 m0, 73728
s_sub_u32 s75, s70, 40960
buffer_load_dwordx4 v8, s[48:51], s75 offen offset:0 lds
ds_write_b128 v52, v[116:119] offset:4416
buffer_load_dwordx4 v9, s[48:51], s75 offen offset:1024 lds
ds_write_b128 v52, v[120:123] offset:4480
buffer_load_dwordx4 v10, s[48:51], s75 offen offset:2048 lds
ds_write_b128 v52, v[124:127] offset:4544
buffer_load_dwordx4 v11, s[48:51], s75 offen offset:3072 lds
ds_read_b128 v[208:211], v53 offset:4352
ds_read_b128 v[212:215], v53 offset:5440
ds_read_b128 v[216:219], v53 offset:6528
ds_read_b128 v[220:223], v53 offset:7616
s_mov_b32 m0, 77824
s_sub_u32 s75, s70, 0
buffer_load_dwordx4 v8, s[48:51], s75 offen offset:0 lds
buffer_load_dwordx4 v9, s[48:51], s75 offen offset:1024 lds
buffer_load_dwordx4 v10, s[48:51], s75 offen offset:2048 lds
buffer_load_dwordx4 v11, s[48:51], s75 offen offset:3072 lds
s_add_u32 s76, s90, 0
s_waitcnt lgkmcnt(15)
s_nop 0
buffer_store_dwordx4 v[160:163], v54, s[56:59], s76 offen sc1
s_add_u32 s76, s90, 17408
buffer_store_dwordx4 v[164:167], v54, s[56:59], s76 offen sc1
s_add_u32 s76, s90, 34816
buffer_store_dwordx4 v[168:171], v54, s[56:59], s76 offen sc1
s_add_u32 s76, s90, 52224
buffer_store_dwordx4 v[172:175], v54, s[56:59], s76 offen sc1
s_add_u32 s76, s90, 69632
buffer_store_dwordx4 v[176:179], v54, s[56:59], s76 offen sc1
s_add_u32 s76, s90, 87040
buffer_store_dwordx4 v[180:183], v54, s[56:59], s76 offen sc1
s_add_u32 s76, s90, 104448
buffer_store_dwordx4 v[184:187], v54, s[56:59], s76 offen sc1
s_add_u32 s76, s90, 121856
buffer_store_dwordx4 v[188:191], v54, s[56:59], s76 offen sc1
s_add_u32 s76, s90, 139264
s_waitcnt lgkmcnt(11)
buffer_store_dwordx4 v[192:195], v54, s[56:59], s76 offen sc1
s_add_u32 s76, s90, 156672
s_waitcnt lgkmcnt(10)
buffer_store_dwordx4 v[196:199], v54, s[56:59], s76 offen sc1
s_add_u32 s76, s90, 174080
s_waitcnt lgkmcnt(9)
buffer_store_dwordx4 v[200:203], v54, s[56:59], s76 offen sc1
s_add_u32 s76, s90, 191488
s_waitcnt lgkmcnt(8)
buffer_store_dwordx4 v[204:207], v54, s[56:59], s76 offen sc1
s_add_u32 s76, s90, 208896
s_waitcnt lgkmcnt(3)
buffer_store_dwordx4 v[208:211], v54, s[56:59], s76 offen sc1
s_add_u32 s76, s90, 226304
s_waitcnt lgkmcnt(2)
buffer_store_dwordx4 v[212:215], v54, s[56:59], s76 offen sc1
s_add_u32 s76, s90, 243712
s_waitcnt lgkmcnt(1)
buffer_store_dwordx4 v[216:219], v54, s[56:59], s76 offen sc1
s_add_u32 s76, s90, 261120
s_waitcnt lgkmcnt(0)
buffer_store_dwordx4 v[220:223], v54, s[56:59], s76 offen sc1
Lb_done:
v_add_u32 v48, 135168, v5
s_waitcnt vmcnt(63)
Lg1:
s_barrier
s_cmp_eq_u32 s14, 27
s_cbranch_scc1 Lg1gate
ds_read_b64_tr_b16 a[192:193], v20 offset:16384
ds_read_b128 a[208:211], v16 offset:0
ds_read_b64_tr_b16 a[194:195], v20 offset:17408
ds_read_b128 a[212:215], v16 offset:2048
ds_read_b64_tr_b16 a[196:197], v21 offset:16384
ds_read_b128 a[216:219], v16 offset:4096
ds_read_b64_tr_b16 a[198:199], v21 offset:17408
ds_read_b128 a[220:223], v16 offset:6144
ds_read_b64_tr_b16 a[200:201], v22 offset:16384
ds_read_b64_tr_b16 a[202:203], v22 offset:17408
ds_read_b64_tr_b16 a[204:205], v23 offset:16384
ds_read_b64_tr_b16 a[206:207], v23 offset:17408
s_waitcnt lgkmcnt(4)
v_mfma_f32_16x16x32_bf16 v[64:67], a[192:195], a[208:211], 0
ds_read_b64_tr_b16 a[224:225], v20 offset:24576
s_lshr_b32 s73, s101, 1
v_mfma_f32_16x16x32_bf16 v[68:71], a[192:195], a[212:215], 0
ds_read_b128 a[240:243], v17 offset:0
s_add_u32 m0, s72, 81920
v_mfma_f32_16x16x32_bf16 v[72:75], a[192:195], a[216:219], 0
ds_read_b64_tr_b16 a[226:227], v20 offset:25600
buffer_load_dwordx4 v12, s[52:55], s71 offen offset:0 lds
v_mfma_f32_16x16x32_bf16 v[76:79], a[192:195], a[220:223], 0
ds_read_b128 a[244:247], v17 offset:2048
v_bfe_u32 v6, v1, 1, 2
v_mfma_f32_16x16x32_bf16 v[80:83], a[196:199], a[208:211], 0
ds_read_b64_tr_b16 a[228:229], v21 offset:24576
v_add_u32_e64 v6, s73, v6
v_mfma_f32_16x16x32_bf16 v[84:87], a[196:199], a[212:215], 0
ds_read_b128 a[248:251], v17 offset:4096
v_mul_u32_u24_e64 v6, 5, v6
v_mfma_f32_16x16x32_bf16 v[88:91], a[196:199], a[216:219], 0
ds_read_b64_tr_b16 a[230:231], v21 offset:25600
buffer_load_dwordx4 v13, s[52:55], s71 offen offset:1024 lds
v_mfma_f32_16x16x32_bf16 v[92:95], a[196:199], a[220:223], 0
ds_read_b128 a[252:255], v17 offset:6144
s_waitcnt lgkmcnt(8)
v_mfma_f32_16x16x32_bf16 v[96:99], a[200:203], a[208:211], 0
ds_read_b64_tr_b16 a[232:233], v22 offset:24576
s_add_u32 s12, s12, 1
s_cmp_eq_u32 s12, 10
s_cselect_b32 s78, 9, -1
v_mfma_f32_16x16x32_bf16 v[100:103], a[200:203], a[212:215], 0
ds_read_b64_tr_b16 a[234:235], v22 offset:25600
s_mul_i32 s79, s78, 128
s_sub_u32 s70, s70, s79
v_mfma_f32_16x16x32_bf16 v[104:107], a[200:203], a[216:219], 0
ds_read_b64_tr_b16 a[236:237], v23 offset:24576
buffer_load_dwordx4 v14, s[52:55], s71 offen offset:2048 lds
v_mfma_f32_16x16x32_bf16 v[108:111], a[200:203], a[220:223], 0
ds_read_b64_tr_b16 a[238:239], v23 offset:25600
s_cmp_eq_u32 s12, 10
s_cselect_b32 s12, 0, s12
v_mfma_f32_16x16x32_bf16 v[112:115], a[204:207], a[208:211], 0
s_mul_i32 s74, s11, 5
v_and_b32_e64 v7, 1, v1
v_mfma_f32_16x16x32_bf16 v[116:119], a[204:207], a[212:215], 0
v_lshl_add_u32 v7, v7, 2, s74
v_lshrrev_b32_e64 v7, 3, v7
v_mfma_f32_16x16x32_bf16 v[120:123], a[204:207], a[216:219], 0
buffer_load_dwordx4 v15, s[52:55], s71 offen offset:3072 lds
v_add_lshl_u32 v6, v6, v7, 6
v_mfma_f32_16x16x32_bf16 v[124:127], a[204:207], a[220:223], 0
s_mul_i32 s79, s78, 221184
s_sub_u32 s71, s71, s79
s_waitcnt lgkmcnt(4)
v_mfma_f32_16x16x32_bf16 v[64:67], a[224:227], a[240:243], v[64:67]
v_add_u32 v229, 16384, v6
s_lshr_b32 s74, s80, 6
v_mfma_f32_16x16x32_bf16 v[68:71], a[224:227], a[244:247], v[68:71]
s_lshl_b32 s74, s74, 10
s_add_u32 s74, s74, 4096
v_mfma_f32_16x16x32_bf16 v[72:75], a[224:227], a[248:251], v[72:75]
v_lshl_add_u32 v6, v2, 6, s74
v_cmp_lt_u32 vcc, 31, v1
s_nop 1
v_cndmask_b32_e64 v229, v229, v6, vcc
v_mfma_f32_16x16x32_bf16 v[76:79], a[224:227], a[252:255], v[76:79]
v_and_b32 v6, 3, v1
s_waitcnt lgkmcnt(0)
s_waitcnt vmcnt(36)
s_barrier
v_mfma_f32_16x16x32_bf16 v[80:83], a[228:231], a[240:243], v[80:83]
ds_read_b64_tr_b16 a[192:193], v20 offset:49152
v_add_u32_e64 v6, s73, v6
v_mfma_f32_16x16x32_bf16 v[84:87], a[228:231], a[244:247], v[84:87]
ds_read_b128 a[208:211], v16 offset:32768
s_add_u32 m0, s72, 0
v_mfma_f32_16x16x32_bf16 v[88:91], a[228:231], a[248:251], v[88:91]
ds_read_b64_tr_b16 a[194:195], v20 offset:50176
buffer_load_dwordx4 v8, s[48:51], s70 offen offset:0 lds
v_mfma_f32_16x16x32_bf16 v[92:95], a[228:231], a[252:255], v[92:95]
ds_read_b128 a[212:215], v16 offset:34816
v_mfma_f32_16x16x32_bf16 v[96:99], a[232:235], a[240:243], v[96:99]
ds_read_b64_tr_b16 a[196:197], v21 offset:49152
v_and_b32 v7, 4, v1
v_mfma_f32_16x16x32_bf16 v[100:103], a[232:235], a[244:247], v[100:103]
ds_read_b128 a[216:219], v16 offset:36864
v_lshl_add_u32 v6, v7, 3, v6
v_mfma_f32_16x16x32_bf16 v[104:107], a[232:235], a[248:251], v[104:107]
ds_read_b64_tr_b16 a[198:199], v21 offset:50176
buffer_load_dwordx4 v9, s[48:51], s70 offen offset:1024 lds
v_mfma_f32_16x16x32_bf16 v[108:111], a[232:235], a[252:255], v[108:111]
ds_read_b128 a[220:223], v16 offset:38912
v_cmp_gt_u32 vcc, 8, v1
s_lshl_b32 s73, s10, 5
s_nop 0
v_cndmask_b32 v6, 27, v6, vcc
v_mfma_f32_16x16x32_bf16 v[112:115], a[236:239], a[240:243], v[112:115]
ds_read_b64_tr_b16 a[200:201], v22 offset:49152
v_xor_b32_e64 v6, s73, v6
v_mfma_f32_16x16x32_bf16 v[116:119], a[236:239], a[244:247], v[116:119]
ds_read_b64_tr_b16 a[202:203], v22 offset:50176
v_lshlrev_b32_e64 v6, 6, v6
v_mfma_f32_16x16x32_bf16 v[120:123], a[236:239], a[248:251], v[120:123]
ds_read_b64_tr_b16 a[204:205], v23 offset:49152
buffer_load_dwordx4 v10, s[48:51], s70 offen offset:2048 lds
v_mfma_f32_16x16x32_bf16 v[124:127], a[236:239], a[252:255], v[124:127]
ds_read_b64_tr_b16 a[206:207], v23 offset:50176
s_waitcnt lgkmcnt(4)
v_mfma_f32_16x16x32_bf16 v[64:67], a[192:195], a[208:211], v[64:67]
ds_read_b64_tr_b16 a[224:225], v20 offset:57344
v_add_u32 v230, 32768, v6
v_mfma_f32_16x16x32_bf16 v[68:71], a[192:195], a[212:215], v[68:71]
ds_read_b128 a[240:243], v17 offset:32768
s_lshl_b32 s74, s101, 10
v_mfma_f32_16x16x32_bf16 v[72:75], a[192:195], a[216:219], v[72:75]
ds_read_b64_tr_b16 a[226:227], v20 offset:58368
buffer_load_dwordx4 v11, s[48:51], s70 offen offset:3072 lds
v_mfma_f32_16x16x32_bf16 v[76:79], a[192:195], a[220:223], v[76:79]
ds_read_b128 a[244:247], v17 offset:34816
s_add_u32 s74, s74, 10485760
v_mfma_f32_16x16x32_bf16 v[80:83], a[196:199], a[208:211], v[80:83]
ds_read_b64_tr_b16 a[228:229], v21 offset:57344
s_add_u32 s73, s93, 1
v_mfma_f32_16x16x32_bf16 v[84:87], a[196:199], a[212:215], v[84:87]
ds_read_b128 a[248:251], v17 offset:36864
s_add_u32 m0, s72, 16384
v_mfma_f32_16x16x32_bf16 v[88:91], a[196:199], a[216:219], v[88:91]
ds_read_b64_tr_b16 a[230:231], v21 offset:58368
buffer_load_dwordx4 v12, s[52:55], s71 offen offset:0 lds
v_mfma_f32_16x16x32_bf16 v[92:95], a[196:199], a[220:223], v[92:95]
ds_read_b128 a[252:255], v17 offset:38912
s_waitcnt lgkmcnt(8)
v_mfma_f32_16x16x32_bf16 v[96:99], a[200:203], a[208:211], v[96:99]
ds_read_b64_tr_b16 a[232:233], v22 offset:57344
s_and_b32 s73, s73, 3
v_mfma_f32_16x16x32_bf16 v[100:103], a[200:203], a[212:215], v[100:103]
ds_read_b64_tr_b16 a[234:235], v22 offset:58368
s_lshl2_add_u32 s22, s10, s73
v_mfma_f32_16x16x32_bf16 v[104:107], a[200:203], a[216:219], v[104:107]
ds_read_b64_tr_b16 a[236:237], v23 offset:57344
buffer_load_dwordx4 v13, s[52:55], s71 offen offset:1024 lds
v_mfma_f32_16x16x32_bf16 v[108:111], a[200:203], a[220:223], v[108:111]
ds_read_b64_tr_b16 a[238:239], v23 offset:58368
s_xor_b32 s18, s22, 4
v_mfma_f32_16x16x32_bf16 v[112:115], a[204:207], a[208:211], v[112:115]
s_add_u32 s12, s12, 1
s_cmp_eq_u32 s12, 10
s_cselect_b32 s78, 9, -1
v_mfma_f32_16x16x32_bf16 v[116:119], a[204:207], a[212:215], v[116:119]
s_mul_i32 s79, s78, 128
s_sub_u32 s70, s70, s79
v_mfma_f32_16x16x32_bf16 v[120:123], a[204:207], a[216:219], v[120:123]
buffer_load_dwordx4 v14, s[52:55], s71 offen offset:2048 lds
s_mul_i32 s18, s18, 57344
v_mfma_f32_16x16x32_bf16 v[124:127], a[204:207], a[220:223], v[124:127]
s_cmp_eq_u32 s12, 10
s_cselect_b32 s12, 0, s12
s_waitcnt lgkmcnt(4)
v_mfma_f32_16x16x32_bf16 v[64:67], a[224:227], a[240:243], v[64:67]
s_add_u32 s18, s18, s74
s_mul_i32 s22, s22, 57344
v_mfma_f32_16x16x32_bf16 v[68:71], a[224:227], a[244:247], v[68:71]
s_add_u32 s22, s22, s74
s_mul_i32 s73, s73, 15360
v_mfma_f32_16x16x32_bf16 v[72:75], a[224:227], a[248:251], v[72:75]
buffer_load_dwordx4 v15, s[52:55], s71 offen offset:3072 lds
v_add_u32_e64 v231, s73, v5
v_mfma_f32_16x16x32_bf16 v[76:79], a[224:227], a[252:255], v[76:79]
s_mul_i32 s79, s78, 221184
s_sub_u32 s71, s71, s79
s_waitcnt lgkmcnt(0)
s_waitcnt vmcnt(8)
s_barrier
s_mov_b64 exec, 1
buffer_store_dwordx2 v[60:61], off, s[64:67], s83 sc1
s_mov_b64 exec, -1
v_mfma_f32_16x16x32_bf16 v[80:83], a[228:231], a[240:243], v[80:83]
ds_read_b64_tr_b16 a[192:193], v24 offset:16384
s_add_u32 s73, s93, 2
v_mfma_f32_16x16x32_bf16 v[84:87], a[228:231], a[244:247], v[84:87]
ds_read_b128 a[208:211], v18 offset:0
s_add_u32 m0, s72, 32768
v_mfma_f32_16x16x32_bf16 v[88:91], a[228:231], a[248:251], v[88:91]
ds_read_b64_tr_b16 a[194:195], v24 offset:17408
buffer_load_dwordx4 v8, s[48:51], s70 offen offset:0 lds
v_mfma_f32_16x16x32_bf16 v[92:95], a[228:231], a[252:255], v[92:95]
ds_read_b128 a[212:215], v18 offset:2048
v_mfma_f32_16x16x32_bf16 v[96:99], a[232:235], a[240:243], v[96:99]
ds_read_b64_tr_b16 a[196:197], v25 offset:16384
s_and_b32 s73, s73, 3
v_mfma_f32_16x16x32_bf16 v[100:103], a[232:235], a[244:247], v[100:103]
ds_read_b128 a[216:219], v18 offset:4096
s_lshl2_add_u32 s23, s10, s73
v_mfma_f32_16x16x32_bf16 v[104:107], a[232:235], a[248:251], v[104:107]
ds_read_b64_tr_b16 a[198:199], v25 offset:17408
buffer_load_dwordx4 v9, s[48:51], s70 offen offset:1024 lds
v_mfma_f32_16x16x32_bf16 v[108:111], a[232:235], a[252:255], v[108:111]
ds_read_b128 a[220:223], v18 offset:6144
s_xor_b32 s19, s23, 4
v_mfma_f32_16x16x32_bf16 v[112:115], a[236:239], a[240:243], v[112:115]
ds_read_b64_tr_b16 a[200:201], v26 offset:16384
s_mul_i32 s19, s19, 57344
v_mfma_f32_16x16x32_bf16 v[116:119], a[236:239], a[244:247], v[116:119]
ds_read_b64_tr_b16 a[202:203], v26 offset:17408
s_add_u32 s19, s19, s74
v_mfma_f32_16x16x32_bf16 v[120:123], a[236:239], a[248:251], v[120:123]
ds_read_b64_tr_b16 a[204:205], v27 offset:16384
buffer_load_dwordx4 v10, s[48:51], s70 offen offset:2048 lds
v_mfma_f32_16x16x32_bf16 v[124:127], a[236:239], a[252:255], v[124:127]
ds_read_b64_tr_b16 a[206:207], v27 offset:17408
s_waitcnt lgkmcnt(4)
v_mfma_f32_16x16x32_bf16 v[64:67], a[192:195], a[208:211], v[64:67]
ds_read_b64_tr_b16 a[224:225], v24 offset:24576
s_mul_i32 s23, s23, 57344
v_mfma_f32_16x16x32_bf16 v[68:71], a[192:195], a[212:215], v[68:71]
ds_read_b128 a[240:243], v19 offset:0
s_add_u32 s23, s23, s74
v_mfma_f32_16x16x32_bf16 v[72:75], a[192:195], a[216:219], v[72:75]
ds_read_b64_tr_b16 a[226:227], v24 offset:25600
buffer_load_dwordx4 v11, s[48:51], s70 offen offset:3072 lds
v_mfma_f32_16x16x32_bf16 v[76:79], a[192:195], a[220:223], v[76:79]
ds_read_b128 a[244:247], v19 offset:2048
s_mul_i32 s73, s73, 15360
v_mfma_f32_16x16x32_bf16 v[80:83], a[196:199], a[208:211], v[80:83]
ds_read_b64_tr_b16 a[228:229], v25 offset:24576
v_add_u32 v232, s73, v5
v_mfma_f32_16x16x32_bf16 v[84:87], a[196:199], a[212:215], v[84:87]
ds_read_b128 a[248:251], v19 offset:4096
s_add_u32 m0, s72, 49152
v_mfma_f32_16x16x32_bf16 v[88:91], a[196:199], a[216:219], v[88:91]
ds_read_b64_tr_b16 a[230:231], v25 offset:25600
buffer_load_dwordx4 v12, s[52:55], s71 offen offset:0 lds
v_mfma_f32_16x16x32_bf16 v[92:95], a[196:199], a[220:223], v[92:95]
ds_read_b128 a[252:255], v19 offset:6144
s_waitcnt lgkmcnt(8)
v_mfma_f32_16x16x32_bf16 v[96:99], a[200:203], a[208:211], v[96:99]
ds_read_b64_tr_b16 a[232:233], v26 offset:24576
s_add_u32 s73, s93, 3
v_mfma_f32_16x16x32_bf16 v[100:103], a[200:203], a[212:215], v[100:103]
ds_read_b64_tr_b16 a[234:235], v26 offset:25600
s_and_b32 s73, s73, 3
v_mfma_f32_16x16x32_bf16 v[104:107], a[200:203], a[216:219], v[104:107]
ds_read_b64_tr_b16 a[236:237], v27 offset:24576
buffer_load_dwordx4 v13, s[52:55], s71 offen offset:1024 lds
v_mfma_f32_16x16x32_bf16 v[108:111], a[200:203], a[220:223], v[108:111]
ds_read_b64_tr_b16 a[238:239], v27 offset:25600
s_lshl2_add_u32 s24, s10, s73
v_mfma_f32_16x16x32_bf16 v[112:115], a[204:207], a[208:211], v[112:115]
s_add_u32 s12, s12, 1
s_cmp_eq_u32 s12, 10
s_cselect_b32 s78, 9, -1
v_mfma_f32_16x16x32_bf16 v[116:119], a[204:207], a[212:215], v[116:119]
s_mul_i32 s79, s78, 128
s_sub_u32 s70, s70, s79
v_mfma_f32_16x16x32_bf16 v[120:123], a[204:207], a[216:219], v[120:123]
buffer_load_dwordx4 v14, s[52:55], s71 offen offset:2048 lds
s_xor_b32 s20, s24, 4
v_mfma_f32_16x16x32_bf16 v[124:127], a[204:207], a[220:223], v[124:127]
s_cmp_eq_u32 s12, 10
s_cselect_b32 s12, 0, s12
s_waitcnt lgkmcnt(4)
v_mfma_f32_16x16x32_bf16 v[64:67], a[224:227], a[240:243], v[64:67]
s_mul_i32 s20, s20, 57344
s_add_u32 s20, s20, s74
v_mfma_f32_16x16x32_bf16 v[68:71], a[224:227], a[244:247], v[68:71]
s_mul_i32 s24, s24, 57344
s_add_u32 s24, s24, s74
v_mfma_f32_16x16x32_bf16 v[72:75], a[224:227], a[248:251], v[72:75]
buffer_load_dwordx4 v15, s[52:55], s71 offen offset:3072 lds
s_mul_i32 s73, s73, 15360
v_mfma_f32_16x16x32_bf16 v[76:79], a[224:227], a[252:255], v[76:79]
s_mul_i32 s79, s78, 221184
s_sub_u32 s71, s71, s79
s_waitcnt lgkmcnt(0)
s_waitcnt vmcnt(9)
s_barrier
v_mfma_f32_16x16x32_bf16 v[80:83], a[228:231], a[240:243], v[80:83]
ds_read_b64_tr_b16 a[192:193], v20 offset:16384
v_add_u32_e64 v233, s73, v5
v_mfma_f32_16x16x32_bf16 v[84:87], a[228:231], a[244:247], v[84:87]
ds_read_b128 a[208:211], v16 offset:0
s_add_u32 m0, s72, 65536
v_mfma_f32_16x16x32_bf16 v[88:91], a[228:231], a[248:251], v[88:91]
ds_read_b64_tr_b16 a[194:195], v20 offset:17408
buffer_load_dwordx4 v8, s[48:51], s70 offen offset:0 lds
v_mfma_f32_16x16x32_bf16 v[92:95], a[228:231], a[252:255], v[92:95]
ds_read_b128 a[212:215], v16 offset:2048
v_mfma_f32_16x16x32_bf16 v[96:99], a[232:235], a[240:243], v[96:99]
ds_read_b64_tr_b16 a[196:197], v21 offset:16384
s_add_u32 s73, s93, 4
v_mfma_f32_16x16x32_bf16 v[100:103], a[232:235], a[244:247], v[100:103]
ds_read_b128 a[216:219], v16 offset:4096
s_and_b32 s73, s73, 3
v_mfma_f32_16x16x32_bf16 v[104:107], a[232:235], a[248:251], v[104:107]
ds_read_b64_tr_b16 a[198:199], v21 offset:17408
buffer_load_dwordx4 v9, s[48:51], s70 offen offset:1024 lds
v_mfma_f32_16x16x32_bf16 v[108:111], a[232:235], a[252:255], v[108:111]
ds_read_b128 a[220:223], v16 offset:6144
s_lshl2_add_u32 s25, s10, s73
v_mfma_f32_16x16x32_bf16 v[112:115], a[236:239], a[240:243], v[112:115]
ds_read_b64_tr_b16 a[200:201], v22 offset:16384
s_xor_b32 s21, s25, 4
v_mfma_f32_16x16x32_bf16 v[116:119], a[236:239], a[244:247], v[116:119]
ds_read_b64_tr_b16 a[202:203], v22 offset:17408
s_mul_i32 s21, s21, 57344
v_mfma_f32_16x16x32_bf16 v[120:123], a[236:239], a[248:251], v[120:123]
ds_read_b64_tr_b16 a[204:205], v23 offset:16384
buffer_load_dwordx4 v10, s[48:51], s70 offen offset:2048 lds
v_mfma_f32_16x16x32_bf16 v[124:127], a[236:239], a[252:255], v[124:127]
ds_read_b64_tr_b16 a[206:207], v23 offset:17408
s_waitcnt lgkmcnt(4)
v_mfma_f32_16x16x32_bf16 v[64:67], a[192:195], a[208:211], v[64:67]
ds_read_b64_tr_b16 a[224:225], v20 offset:24576
s_add_u32 s21, s21, s74
v_mfma_f32_16x16x32_bf16 v[68:71], a[192:195], a[212:215], v[68:71]
ds_read_b128 a[240:243], v17 offset:0
s_mul_i32 s25, s25, 57344
v_mfma_f32_16x16x32_bf16 v[72:75], a[192:195], a[216:219], v[72:75]
ds_read_b64_tr_b16 a[226:227], v20 offset:25600
buffer_load_dwordx4 v11, s[48:51], s70 offen offset:3072 lds
v_mfma_f32_16x16x32_bf16 v[76:79], a[192:195], a[220:223], v[76:79]
ds_read_b128 a[244:247], v17 offset:2048
s_add_u32 s25, s25, s74
v_mfma_f32_16x16x32_bf16 v[80:83], a[196:199], a[208:211], v[80:83]
ds_read_b64_tr_b16 a[228:229], v21 offset:24576
s_mul_i32 s73, s73, 15360
v_mfma_f32_16x16x32_bf16 v[84:87], a[196:199], a[212:215], v[84:87]
ds_read_b128 a[248:251], v17 offset:4096
s_add_u32 m0, s72, 81920
v_mfma_f32_16x16x32_bf16 v[88:91], a[196:199], a[216:219], v[88:91]
ds_read_b64_tr_b16 a[230:231], v21 offset:25600
buffer_load_dwordx4 v12, s[52:55], s71 offen offset:0 lds
v_mfma_f32_16x16x32_bf16 v[92:95], a[196:199], a[220:223], v[92:95]
ds_read_b128 a[252:255], v17 offset:6144
s_waitcnt lgkmcnt(8)
v_mfma_f32_16x16x32_bf16 v[96:99], a[200:203], a[208:211], v[96:99]
ds_read_b64_tr_b16 a[232:233], v22 offset:24576
v_add_u32_e64 v234, s73, v5
v_mfma_f32_16x16x32_bf16 v[100:103], a[200:203], a[212:215], v[100:103]
ds_read_b64_tr_b16 a[234:235], v22 offset:25600
s_mul_i32 s26, s11, 80
v_mfma_f32_16x16x32_bf16 v[104:107], a[200:203], a[216:219], v[104:107]
ds_read_b64_tr_b16 a[236:237], v23 offset:24576
buffer_load_dwordx4 v13, s[52:55], s71 offen offset:1024 lds
v_mfma_f32_16x16x32_bf16 v[108:111], a[200:203], a[220:223], v[108:111]
ds_read_b64_tr_b16 a[238:239], v23 offset:25600
s_mul_i32 s74, s3, 20
v_mfma_f32_16x16x32_bf16 v[112:115], a[204:207], a[208:211], v[112:115]
s_add_u32 s12, s12, 1
s_cmp_eq_u32 s12, 10
s_cselect_b32 s78, 9, -1
v_mfma_f32_16x16x32_bf16 v[116:119], a[204:207], a[212:215], v[116:119]
s_mul_i32 s79, s78, 128
s_sub_u32 s70, s70, s79
v_mfma_f32_16x16x32_bf16 v[120:123], a[204:207], a[216:219], v[120:123]
buffer_load_dwordx4 v14, s[52:55], s71 offen offset:2048 lds
s_add_u32 s26, s26, s74
v_mfma_f32_16x16x32_bf16 v[124:127], a[204:207], a[220:223], v[124:127]
s_cmp_eq_u32 s12, 10
s_cselect_b32 s12, 0, s12
s_waitcnt lgkmcnt(4)
v_mfma_f32_16x16x32_bf16 v[64:67], a[224:227], a[240:243], v[64:67]
v_add_lshl_u32 v6, v1, s26, 6
v_add_u32 v6, 131072, v6
v_mfma_f32_16x16x32_bf16 v[68:71], a[224:227], a[244:247], v[68:71]
s_lshl2_add_u32 s29, s2, s3
s_xor_b32 s34, s29, 4
v_mfma_f32_16x16x32_bf16 v[72:75], a[224:227], a[248:251], v[72:75]
buffer_load_dwordx4 v15, s[52:55], s71 offen offset:3072 lds
s_lshl_b32 s35, s34, 6
v_mfma_f32_16x16x32_bf16 v[76:79], a[224:227], a[252:255], v[76:79]
s_mul_i32 s79, s78, 221184
s_sub_u32 s71, s71, s79
s_waitcnt lgkmcnt(0)
s_waitcnt vmcnt(8)
s_barrier
v_mfma_f32_16x16x32_bf16 v[80:83], a[228:231], a[240:243], v[80:83]
ds_read_b64_tr_b16 a[192:193], v20 offset:49152
s_add_u32 s35, s35, 262144
v_mfma_f32_16x16x32_bf16 v[84:87], a[228:231], a[244:247], v[84:87]
ds_read_b128 a[208:211], v16 offset:32768
s_add_u32 m0, s72, 0
v_mfma_f32_16x16x32_bf16 v[88:91], a[228:231], a[248:251], v[88:91]
ds_read_b64_tr_b16 a[194:195], v20 offset:50176
buffer_load_dwordx4 v8, s[48:51], s70 offen offset:0 lds
v_mfma_f32_16x16x32_bf16 v[92:95], a[228:231], a[252:255], v[92:95]
ds_read_b128 a[212:215], v16 offset:34816
v_mfma_f32_16x16x32_bf16 v[96:99], a[232:235], a[240:243], v[96:99]
ds_read_b64_tr_b16 a[196:197], v21 offset:49152
v_mov_b32 v7, s35
v_mfma_f32_16x16x32_bf16 v[100:103], a[232:235], a[244:247], v[100:103]
ds_read_b128 a[216:219], v16 offset:36864
v_cmp_lt_u32_e64 vcc, 19, v1
s_xor_b32 s35, s35, 256
s_mul_i32 s29, s29, 2560
v_cndmask_b32_e64 v235, v6, v7, vcc
v_mfma_f32_16x16x32_bf16 v[104:107], a[232:235], a[248:251], v[104:107]
ds_read_b64_tr_b16 a[198:199], v21 offset:50176
buffer_load_dwordx4 v9, s[48:51], s70 offen offset:1024 lds
v_mfma_f32_16x16x32_bf16 v[108:111], a[232:235], a[252:255], v[108:111]
ds_read_b128 a[220:223], v16 offset:38912
s_add_u32 s29, s29, 17825792
v_mfma_f32_16x16x32_bf16 v[112:115], a[236:239], a[240:243], v[112:115]
ds_read_b64_tr_b16 a[200:201], v22 offset:49152
s_mul_i32 s34, s34, 2560
v_mfma_f32_16x16x32_bf16 v[116:119], a[236:239], a[244:247], v[116:119]
ds_read_b64_tr_b16 a[202:203], v22 offset:50176
s_add_u32 s34, s34, 17825792
v_mfma_f32_16x16x32_bf16 v[120:123], a[236:239], a[248:251], v[120:123]
ds_read_b64_tr_b16 a[204:205], v23 offset:49152
buffer_load_dwordx4 v10, s[48:51], s70 offen offset:2048 lds
v_mfma_f32_16x16x32_bf16 v[124:127], a[236:239], a[252:255], v[124:127]
ds_read_b64_tr_b16 a[206:207], v23 offset:50176
s_waitcnt lgkmcnt(4)
v_mfma_f32_16x16x32_bf16 v[64:67], a[192:195], a[208:211], v[64:67]
ds_read_b64_tr_b16 a[224:225], v20 offset:57344
v_lshlrev_b32 v240, 3, v1
v_mfma_f32_16x16x32_bf16 v[68:71], a[192:195], a[212:215], v[68:71]
ds_read_b128 a[240:243], v17 offset:32768
s_mul_i32 s26, s26, 4224
v_mfma_f32_16x16x32_bf16 v[72:75], a[192:195], a[216:219], v[72:75]
ds_read_b64_tr_b16 a[226:227], v20 offset:58368
buffer_load_dwordx4 v11, s[48:51], s70 offen offset:3072 lds
v_mfma_f32_16x16x32_bf16 v[76:79], a[192:195], a[220:223], v[76:79]
ds_read_b128 a[244:247], v17 offset:34816
s_lshl_b32 s73, s10, 7
v_mfma_f32_16x16x32_bf16 v[80:83], a[196:199], a[208:211], v[80:83]
ds_read_b64_tr_b16 a[228:229], v21 offset:57344
s_add_u32 s26, s26, s73
v_mfma_f32_16x16x32_bf16 v[84:87], a[196:199], a[212:215], v[84:87]
ds_read_b128 a[248:251], v17 offset:36864
s_add_u32 m0, s72, 16384
v_mfma_f32_16x16x32_bf16 v[88:91], a[196:199], a[216:219], v[88:91]
ds_read_b64_tr_b16 a[230:231], v21 offset:58368
buffer_load_dwordx4 v12, s[52:55], s71 offen offset:0 lds
v_mfma_f32_16x16x32_bf16 v[92:95], a[196:199], a[220:223], v[92:95]
ds_read_b128 a[252:255], v17 offset:38912
s_waitcnt lgkmcnt(8)
v_mfma_f32_16x16x32_bf16 v[96:99], a[200:203], a[208:211], v[96:99]
ds_read_b64_tr_b16 a[232:233], v22 offset:57344
s_add_u32 s26, s26, 4194304
v_mfma_f32_16x16x32_bf16 v[100:103], a[200:203], a[212:215], v[100:103]
ds_read_b64_tr_b16 a[234:235], v22 offset:58368
v_lshrrev_b32 v6, 3, v1
v_mfma_f32_16x16x32_bf16 v[104:107], a[200:203], a[216:219], v[104:107]
ds_read_b64_tr_b16 a[236:237], v23 offset:57344
buffer_load_dwordx4 v13, s[52:55], s71 offen offset:1024 lds
v_mfma_f32_16x16x32_bf16 v[108:111], a[200:203], a[220:223], v[108:111]
ds_read_b64_tr_b16 a[238:239], v23 offset:58368
v_and_b32 v7, 0x70, v5
v_mfma_f32_16x16x32_bf16 v[112:115], a[204:207], a[208:211], v[112:115]
s_add_u32 s12, s12, 1
s_cmp_eq_u32 s12, 10
s_cselect_b32 s78, 9, -1
v_mfma_f32_16x16x32_bf16 v[116:119], a[204:207], a[212:215], v[116:119]
s_mul_i32 s79, s78, 128
s_sub_u32 s70, s70, s79
v_mfma_f32_16x16x32_bf16 v[120:123], a[204:207], a[216:219], v[120:123]
buffer_load_dwordx4 v14, s[52:55], s71 offen offset:2048 lds
v_mul_u32_u24 v236, 4224, v6
v_mfma_f32_16x16x32_bf16 v[124:127], a[204:207], a[220:223], v[124:127]
s_cmp_eq_u32 s12, 10
s_cselect_b32 s12, 0, s12
s_waitcnt lgkmcnt(4)
v_mfma_f32_16x16x32_bf16 v[64:67], a[224:227], a[240:243], v[64:67]
v_add_u32 v236, v236, v7
v_add_u32_e64 v6, s74, v6
v_mfma_f32_16x16x32_bf16 v[68:71], a[224:227], a[244:247], v[68:71]
v_mul_u32_u24 v6, 160, v6
v_add_u32 v6, 122880, v6
v_mfma_f32_16x16x32_bf16 v[72:75], a[224:227], a[248:251], v[72:75]
buffer_load_dwordx4 v15, s[52:55], s71 offen offset:3072 lds
v_add_u32_e64 v237, v6, v7
v_mfma_f32_16x16x32_bf16 v[76:79], a[224:227], a[252:255], v[76:79]
s_mul_i32 s79, s78, 221184
s_sub_u32 s71, s71, s79
s_waitcnt lgkmcnt(0)
s_waitcnt vmcnt(8)
s_barrier
v_mfma_f32_16x16x32_bf16 v[80:83], a[228:231], a[240:243], v[80:83]
ds_read_b64_tr_b16 a[192:193], v24 offset:16384
v_lshrrev_b32_e64 v6, 2, v1
v_mfma_f32_16x16x32_bf16 v[84:87], a[228:231], a[244:247], v[84:87]
ds_read_b128 a[208:211], v18 offset:0
s_add_u32 m0, s72, 32768
v_mfma_f32_16x16x32_bf16 v[88:91], a[228:231], a[248:251], v[88:91]
ds_read_b64_tr_b16 a[194:195], v24 offset:17408
buffer_load_dwordx4 v8, s[48:51], s70 offen offset:0 lds
v_mfma_f32_16x16x32_bf16 v[92:95], a[228:231], a[252:255], v[92:95]
ds_read_b128 a[212:215], v18 offset:2048
v_mfma_f32_16x16x32_bf16 v[96:99], a[232:235], a[240:243], v[96:99]
ds_read_b64_tr_b16 a[196:197], v25 offset:16384
v_mul_u32_u24 v6, 160, v6
v_mfma_f32_16x16x32_bf16 v[100:103], a[232:235], a[244:247], v[100:103]
ds_read_b128 a[216:219], v18 offset:4096
v_and_b32_e64 v7, 0x18, v240
v_mfma_f32_16x16x32_bf16 v[104:107], a[232:235], a[248:251], v[104:107]
ds_read_b64_tr_b16 a[198:199], v25 offset:17408
buffer_load_dwordx4 v9, s[48:51], s70 offen offset:1024 lds
v_mfma_f32_16x16x32_bf16 v[108:111], a[232:235], a[252:255], v[108:111]
ds_read_b128 a[220:223], v18 offset:6144
s_lshl_b32 s73, s93, 5
v_mfma_f32_16x16x32_bf16 v[112:115], a[236:239], a[240:243], v[112:115]
ds_read_b64_tr_b16 a[200:201], v26 offset:16384
s_add_u32 s73, s73, 122880
v_mfma_f32_16x16x32_bf16 v[116:119], a[236:239], a[244:247], v[116:119]
ds_read_b64_tr_b16 a[202:203], v26 offset:17408
v_add3_u32 v238, v6, v7, s73
v_mfma_f32_16x16x32_bf16 v[120:123], a[236:239], a[248:251], v[120:123]
ds_read_b64_tr_b16 a[204:205], v27 offset:16384
buffer_load_dwordx4 v10, s[48:51], s70 offen offset:2048 lds
v_mfma_f32_16x16x32_bf16 v[124:127], a[236:239], a[252:255], v[124:127]
ds_read_b64_tr_b16 a[206:207], v27 offset:17408
s_waitcnt lgkmcnt(4)
v_mfma_f32_16x16x32_bf16 v[64:67], a[192:195], a[208:211], v[64:67]
ds_read_b64_tr_b16 a[224:225], v24 offset:24576
s_mul_i32 s73, s3, 2816
v_mfma_f32_16x16x32_bf16 v[68:71], a[192:195], a[212:215], v[68:71]
ds_read_b128 a[240:243], v19 offset:0
v_mul_u32_u24 v6, 176, v2
v_mfma_f32_16x16x32_bf16 v[72:75], a[192:195], a[216:219], v[72:75]
ds_read_b64_tr_b16 a[226:227], v24 offset:25600
buffer_load_dwordx4 v11, s[48:51], s70 offen offset:3072 lds
v_mfma_f32_16x16x32_bf16 v[76:79], a[192:195], a[220:223], v[76:79]
ds_read_b128 a[244:247], v19 offset:2048
v_lshl_add_u32 v6, v3, 3, v6
v_mfma_f32_16x16x32_bf16 v[80:83], a[196:199], a[208:211], v[80:83]
ds_read_b64_tr_b16 a[228:229], v25 offset:24576
v_add_u32_e64 v241, s73, v6
v_mfma_f32_16x16x32_bf16 v[84:87], a[196:199], a[212:215], v[84:87]
ds_read_b128 a[248:251], v19 offset:4096
s_add_u32 m0, s72, 49152
v_mfma_f32_16x16x32_bf16 v[88:91], a[196:199], a[216:219], v[88:91]
ds_read_b64_tr_b16 a[230:231], v25 offset:25600
buffer_load_dwordx4 v12, s[52:55], s71 offen offset:0 lds
v_mfma_f32_16x16x32_bf16 v[92:95], a[196:199], a[220:223], v[92:95]
ds_read_b128 a[252:255], v19 offset:6144
s_waitcnt lgkmcnt(8)
v_mfma_f32_16x16x32_bf16 v[96:99], a[200:203], a[208:211], v[96:99]
ds_read_b64_tr_b16 a[232:233], v26 offset:24576
v_add_u32 v239, 0, v1
v_mfma_f32_16x16x32_bf16 v[100:103], a[200:203], a[212:215], v[100:103]
ds_read_b64_tr_b16 a[234:235], v26 offset:25600
v_mul_u32_u24 v6, 6554, v239
v_mfma_f32_16x16x32_bf16 v[104:107], a[200:203], a[216:219], v[104:107]
ds_read_b64_tr_b16 a[236:237], v27 offset:24576
buffer_load_dwordx4 v13, s[52:55], s71 offen offset:1024 lds
v_mfma_f32_16x16x32_bf16 v[108:111], a[200:203], a[220:223], v[108:111]
ds_read_b64_tr_b16 a[238:239], v27 offset:25600
v_lshrrev_b32_e64 v6, 16, v6
v_mfma_f32_16x16x32_bf16 v[112:115], a[204:207], a[208:211], v[112:115]
s_add_u32 s12, s12, 1
s_cmp_eq_u32 s12, 10
s_cselect_b32 s78, 9, -1
v_mfma_f32_16x16x32_bf16 v[116:119], a[204:207], a[212:215], v[116:119]
s_mul_i32 s79, s78, 128
s_sub_u32 s70, s70, s79
v_mfma_f32_16x16x32_bf16 v[120:123], a[204:207], a[216:219], v[120:123]
buffer_load_dwordx4 v14, s[52:55], s71 offen offset:2048 lds
v_add_lshl_u32 v7, v239, v6, 4
v_mfma_f32_16x16x32_bf16 v[124:127], a[204:207], a[220:223], v[124:127]
s_cmp_eq_u32 s12, 10
s_cselect_b32 s12, 0, s12
s_waitcnt lgkmcnt(4)
v_mfma_f32_16x16x32_bf16 v[64:67], a[224:227], a[240:243], v[64:67]
v_add_u32 v242, s73, v7
v_mul_u32_u24 v6, 1104, v6
v_mfma_f32_16x16x32_bf16 v[68:71], a[224:227], a[244:247], v[68:71]
v_add_u32 v245, v6, v7
v_add_u32 v239, 64, v1
v_mfma_f32_16x16x32_bf16 v[72:75], a[224:227], a[248:251], v[72:75]
buffer_load_dwordx4 v15, s[52:55], s71 offen offset:3072 lds
v_mul_u32_u24 v6, 6554, v239
v_mfma_f32_16x16x32_bf16 v[76:79], a[224:227], a[252:255], v[76:79]
s_mul_i32 s79, s78, 221184
s_sub_u32 s71, s71, s79
s_waitcnt lgkmcnt(0)
s_waitcnt vmcnt(8)
s_barrier
v_mfma_f32_16x16x32_bf16 v[80:83], a[228:231], a[240:243], v[80:83]
ds_read_b64_tr_b16 a[192:193], v20 offset:16384
v_lshrrev_b32_e64 v6, 16, v6
v_mfma_f32_16x16x32_bf16 v[84:87], a[228:231], a[244:247], v[84:87]
ds_read_b128 a[208:211], v16 offset:0
s_add_u32 m0, s72, 65536
v_mfma_f32_16x16x32_bf16 v[88:91], a[228:231], a[248:251], v[88:91]
ds_read_b64_tr_b16 a[194:195], v20 offset:17408
buffer_load_dwordx4 v8, s[48:51], s70 offen offset:0 lds
v_mfma_f32_16x16x32_bf16 v[92:95], a[228:231], a[252:255], v[92:95]
ds_read_b128 a[212:215], v16 offset:2048
v_mfma_f32_16x16x32_bf16 v[96:99], a[232:235], a[240:243], v[96:99]
ds_read_b64_tr_b16 a[196:197], v21 offset:16384
v_add_lshl_u32 v7, v239, v6, 4
v_mfma_f32_16x16x32_bf16 v[100:103], a[232:235], a[244:247], v[100:103]
ds_read_b128 a[216:219], v16 offset:4096
v_add_u32_e64 v243, s73, v7
v_mfma_f32_16x16x32_bf16 v[104:107], a[232:235], a[248:251], v[104:107]
ds_read_b64_tr_b16 a[198:199], v21 offset:17408
buffer_load_dwordx4 v9, s[48:51], s70 offen offset:1024 lds
v_mfma_f32_16x16x32_bf16 v[108:111], a[232:235], a[252:255], v[108:111]
ds_read_b128 a[220:223], v16 offset:6144
v_mul_u32_u24 v6, 1104, v6
v_mfma_f32_16x16x32_bf16 v[112:115], a[236:239], a[240:243], v[112:115]
ds_read_b64_tr_b16 a[200:201], v22 offset:16384
v_add_u32_e64 v246, v6, v7
v_mfma_f32_16x16x32_bf16 v[116:119], a[236:239], a[244:247], v[116:119]
ds_read_b64_tr_b16 a[202:203], v22 offset:17408
v_add_u32 v239, 128, v1
v_mfma_f32_16x16x32_bf16 v[120:123], a[236:239], a[248:251], v[120:123]
ds_read_b64_tr_b16 a[204:205], v23 offset:16384
buffer_load_dwordx4 v10, s[48:51], s70 offen offset:2048 lds
v_mfma_f32_16x16x32_bf16 v[124:127], a[236:239], a[252:255], v[124:127]
ds_read_b64_tr_b16 a[206:207], v23 offset:17408
s_waitcnt lgkmcnt(4)
v_mfma_f32_16x16x32_bf16 v[64:67], a[192:195], a[208:211], v[64:67]
ds_read_b64_tr_b16 a[224:225], v20 offset:24576
v_mul_u32_u24 v6, 6554, v239
v_mfma_f32_16x16x32_bf16 v[68:71], a[192:195], a[212:215], v[68:71]
ds_read_b128 a[240:243], v17 offset:0
v_lshrrev_b32 v6, 16, v6
v_mfma_f32_16x16x32_bf16 v[72:75], a[192:195], a[216:219], v[72:75]
ds_read_b64_tr_b16 a[226:227], v20 offset:25600
buffer_load_dwordx4 v11, s[48:51], s70 offen offset:3072 lds
v_mfma_f32_16x16x32_bf16 v[76:79], a[192:195], a[220:223], v[76:79]
ds_read_b128 a[244:247], v17 offset:2048
v_add_lshl_u32 v7, v239, v6, 4
v_mfma_f32_16x16x32_bf16 v[80:83], a[196:199], a[208:211], v[80:83]
ds_read_b64_tr_b16 a[228:229], v21 offset:24576
v_add_u32_e64 v244, s73, v7
v_mfma_f32_16x16x32_bf16 v[84:87], a[196:199], a[212:215], v[84:87]
ds_read_b128 a[248:251], v17 offset:4096
s_add_u32 m0, s72, 81920
v_mfma_f32_16x16x32_bf16 v[88:91], a[196:199], a[216:219], v[88:91]
ds_read_b64_tr_b16 a[230:231], v21 offset:25600
buffer_load_dwordx4 v12, s[52:55], s71 offen offset:0 lds
v_mfma_f32_16x16x32_bf16 v[92:95], a[196:199], a[220:223], v[92:95]
ds_read_b128 a[252:255], v17 offset:6144
s_waitcnt lgkmcnt(8)
v_mfma_f32_16x16x32_bf16 v[96:99], a[200:203], a[208:211], v[96:99]
ds_read_b64_tr_b16 a[232:233], v22 offset:24576
v_mul_u32_u24 v6, 1104, v6
v_mfma_f32_16x16x32_bf16 v[100:103], a[200:203], a[212:215], v[100:103]
ds_read_b64_tr_b16 a[234:235], v22 offset:25600
v_add_u32 v247, v6, v7
v_mfma_f32_16x16x32_bf16 v[104:107], a[200:203], a[216:219], v[104:107]
ds_read_b64_tr_b16 a[236:237], v23 offset:24576
buffer_load_dwordx4 v13, s[52:55], s71 offen offset:1024 lds
v_mfma_f32_16x16x32_bf16 v[108:111], a[200:203], a[220:223], v[108:111]
ds_read_b64_tr_b16 a[238:239], v23 offset:25600
s_lshl2_add_u32 s28, s10, s93
v_mfma_f32_16x16x32_bf16 v[112:115], a[204:207], a[208:211], v[112:115]
s_add_u32 s12, s12, 1
s_cmp_eq_u32 s12, 10
s_cselect_b32 s78, 9, -1
v_mfma_f32_16x16x32_bf16 v[116:119], a[204:207], a[212:215], v[116:119]
s_mul_i32 s79, s78, 128
s_sub_u32 s70, s70, s79
v_mfma_f32_16x16x32_bf16 v[120:123], a[204:207], a[216:219], v[120:123]
buffer_load_dwordx4 v14, s[52:55], s71 offen offset:2048 lds
s_mul_i32 s27, s28, 20480
v_mfma_f32_16x16x32_bf16 v[124:127], a[204:207], a[220:223], v[124:127]
s_cmp_eq_u32 s12, 10
s_cselect_b32 s12, 0, s12
s_waitcnt lgkmcnt(4)
v_mfma_f32_16x16x32_bf16 v[64:67], a[224:227], a[240:243], v[64:67]
s_mul_i32 s73, s11, 160
s_add_u32 s27, s27, s73
v_mfma_f32_16x16x32_bf16 v[68:71], a[224:227], a[244:247], v[68:71]
s_lshl_b32 s28, s28, 6
s_add_u32 s28, s28, 196608
v_mfma_f32_16x16x32_bf16 v[72:75], a[224:227], a[248:251], v[72:75]
buffer_load_dwordx4 v15, s[52:55], s71 offen offset:3072 lds
v_lshlrev_b32_e64 v239, 2, v2
v_mfma_f32_16x16x32_bf16 v[76:79], a[224:227], a[252:255], v[76:79]
s_mul_i32 s79, s78, 221184
s_sub_u32 s71, s71, s79
s_waitcnt lgkmcnt(0)
s_waitcnt vmcnt(8)
s_barrier
v_mfma_f32_16x16x32_bf16 v[80:83], a[228:231], a[240:243], v[80:83]
ds_read_b64_tr_b16 a[192:193], v20 offset:49152
v_lshlrev_b32_e64 v140, 4, v2
v_mfma_f32_16x16x32_bf16 v[84:87], a[228:231], a[244:247], v[84:87]
ds_read_b128 a[208:211], v16 offset:32768
s_add_u32 m0, s72, 0
v_mfma_f32_16x16x32_bf16 v[88:91], a[228:231], a[248:251], v[88:91]
ds_read_b64_tr_b16 a[194:195], v20 offset:50176
buffer_load_dwordx4 v8, s[48:51], s70 offen offset:0 lds
v_mfma_f32_16x16x32_bf16 v[92:95], a[228:231], a[252:255], v[92:95]
ds_read_b128 a[212:215], v16 offset:34816
v_mfma_f32_16x16x32_bf16 v[96:99], a[232:235], a[240:243], v[96:99]
ds_read_b64_tr_b16 a[196:197], v21 offset:49152
buffer_load_dwordx2 v[56:57], v229, s[56:59], 0 offen sc1
v_mfma_f32_16x16x32_bf16 v[100:103], a[232:235], a[244:247], v[100:103]
ds_read_b128 a[216:219], v16 offset:36864
v_lshrrev_b32 v6, 1, v3
v_mfma_f32_16x16x32_bf16 v[104:107], a[232:235], a[248:251], v[104:107]
ds_read_b64_tr_b16 a[198:199], v21 offset:50176
buffer_load_dwordx4 v9, s[48:51], s70 offen offset:1024 lds
v_mfma_f32_16x16x32_bf16 v[108:111], a[232:235], a[252:255], v[108:111]
ds_read_b128 a[220:223], v16 offset:38912
v_lshl_add_u32 v6, v6, 8, v140
v_mfma_f32_16x16x32_bf16 v[112:115], a[236:239], a[240:243], v[112:115]
ds_read_b64_tr_b16 a[200:201], v22 offset:49152
v_and_b32_e64 v7, 1, v3
v_mfma_f32_16x16x32_bf16 v[116:119], a[236:239], a[244:247], v[116:119]
ds_read_b64_tr_b16 a[202:203], v22 offset:50176
v_lshl_add_u32 v6, v7, 3, v6
v_mfma_f32_16x16x32_bf16 v[120:123], a[236:239], a[248:251], v[120:123]
ds_read_b64_tr_b16 a[204:205], v23 offset:49152
buffer_load_dwordx4 v10, s[48:51], s70 offen offset:2048 lds
v_mfma_f32_16x16x32_bf16 v[124:127], a[236:239], a[252:255], v[124:127]
ds_read_b64_tr_b16 a[206:207], v23 offset:50176
s_waitcnt lgkmcnt(4)
v_mfma_f32_16x16x32_bf16 v[64:67], a[192:195], a[208:211], v[64:67]
ds_read_b64_tr_b16 a[224:225], v20 offset:57344
v_sub_u32 v51, s87, v6
v_mfma_f32_16x16x32_bf16 v[68:71], a[192:195], a[212:215], v[68:71]
ds_read_b128 a[240:243], v17 offset:32768
v_lshl_add_u32 v6, v3, 8, v140
v_mfma_f32_16x16x32_bf16 v[72:75], a[192:195], a[216:219], v[72:75]
ds_read_b64_tr_b16 a[226:227], v20 offset:58368
buffer_load_dwordx4 v11, s[48:51], s70 offen offset:3072 lds
v_mfma_f32_16x16x32_bf16 v[76:79], a[192:195], a[220:223], v[76:79]
ds_read_b128 a[244:247], v17 offset:34816
v_sub_u32_e64 v52, s87, v6
v_mfma_f32_16x16x32_bf16 v[80:83], a[196:199], a[208:211], v[80:83]
ds_read_b64_tr_b16 a[228:229], v21 offset:57344
v_lshrrev_b32_e64 v141, 1, v2
v_mfma_f32_16x16x32_bf16 v[84:87], a[196:199], a[212:215], v[84:87]
ds_read_b128 a[248:251], v17 offset:36864
s_add_u32 m0, s72, 16384
v_mfma_f32_16x16x32_bf16 v[88:91], a[196:199], a[216:219], v[88:91]
ds_read_b64_tr_b16 a[230:231], v21 offset:58368
buffer_load_dwordx4 v12, s[52:55], s71 offen offset:0 lds
v_mfma_f32_16x16x32_bf16 v[92:95], a[196:199], a[220:223], v[92:95]
ds_read_b128 a[252:255], v17 offset:38912
s_waitcnt lgkmcnt(8)
v_mfma_f32_16x16x32_bf16 v[96:99], a[200:203], a[208:211], v[96:99]
ds_read_b64_tr_b16 a[232:233], v22 offset:57344
v_and_b32 v142, 1, v2
v_mfma_f32_16x16x32_bf16 v[100:103], a[200:203], a[212:215], v[100:103]
ds_read_b64_tr_b16 a[234:235], v22 offset:58368
v_lshl_add_u32 v6, v3, 4, v141
v_mfma_f32_16x16x32_bf16 v[104:107], a[200:203], a[216:219], v[104:107]
ds_read_b64_tr_b16 a[236:237], v23 offset:57344
buffer_load_dwordx4 v13, s[52:55], s71 offen offset:1024 lds
v_mfma_f32_16x16x32_bf16 v[108:111], a[200:203], a[220:223], v[108:111]
ds_read_b64_tr_b16 a[238:239], v23 offset:58368
v_lshlrev_b32_e64 v6, 2, v6
v_mfma_f32_16x16x32_bf16 v[112:115], a[204:207], a[208:211], v[112:115]
v_lshl_add_u32 v7, v142, 8, s87
v_sub_u32_e64 v53, v7, v6
v_mfma_f32_16x16x32_bf16 v[116:119], a[204:207], a[212:215], v[116:119]
v_lshl_add_u32 v6, v3, 5, v141
v_lshlrev_b32_e64 v6, 2, v6
v_mfma_f32_16x16x32_bf16 v[120:123], a[204:207], a[216:219], v[120:123]
buffer_load_dwordx4 v14, s[52:55], s71 offen offset:2048 lds
s_mul_i32 s74, s80, 4352
s_add_u32 s74, s74, 1048576
v_mfma_f32_16x16x32_bf16 v[124:127], a[204:207], a[220:223], v[124:127]
v_lshl_add_u32 v7, v142, 1, s87
s_waitcnt vmcnt(6)
v_cmp_ne_u64 vcc, s[68:69], v[56:57]
s_cbranch_vccnz Lsp_6
Lsd_7:
s_waitcnt lgkmcnt(4)
v_mfma_f32_16x16x32_bf16 v[64:67], a[224:227], a[240:243], v[64:67]
v_sub_u32 v54, v7, v6
v_mov_b32 v55, s87
v_mfma_f32_16x16x32_bf16 v[68:71], a[224:227], a[244:247], v[68:71]
v_lshlrev_b32 v143, 2, v3
v_sub_u32 v6, v143, v141
v_mfma_f32_16x16x32_bf16 v[72:75], a[224:227], a[248:251], v[72:75]
buffer_load_dwordx4 v15, s[52:55], s71 offen offset:3072 lds
v_lshl_add_u32 v6, v6, 2, s87
v_mfma_f32_16x16x32_bf16 v[76:79], a[224:227], a[252:255], v[76:79]
buffer_load_dwordx4 v[144:147], v5, s[56:59], s74 offen offset:0 sc1
s_waitcnt lgkmcnt(0)
s_barrier
v_mfma_f32_16x16x32_bf16 v[80:83], a[228:231], a[240:243], v[80:83]
ds_read_b64_tr_b16 a[192:193], v24 offset:16384
v_mul_u32_u24 v225, 1216, v142
v_mfma_f32_16x16x32_bf16 v[84:87], a[228:231], a[244:247], v[84:87]
ds_read_b128 a[208:211], v18 offset:0
v_add_u32 v6, 8732, v6
v_mfma_f32_16x16x32_bf16 v[88:91], a[228:231], a[248:251], v[88:91]
ds_read_b64_tr_b16 a[194:195], v24 offset:17408
v_add_u32_e64 v225, v225, v6
v_mfma_f32_16x16x32_bf16 v[92:95], a[228:231], a[252:255], v[92:95]
ds_read_b128 a[212:215], v18 offset:2048
buffer_load_dwordx4 v[148:151], v5, s[56:59], s74 offen offset:1024 sc1
v_mfma_f32_16x16x32_bf16 v[96:99], a[232:235], a[240:243], v[96:99]
ds_read_b64_tr_b16 a[196:197], v25 offset:16384
v_add_u32 v226, 512, v225
v_mfma_f32_16x16x32_bf16 v[100:103], a[232:235], a[244:247], v[100:103]
ds_read_b128 a[216:219], v18 offset:4096
v_sub_u32_e64 v6, v143, v2
v_mfma_f32_16x16x32_bf16 v[104:107], a[232:235], a[248:251], v[104:107]
ds_read_b64_tr_b16 a[198:199], v25 offset:17408
v_lshl_add_u32 v6, v6, 2, s87
v_mfma_f32_16x16x32_bf16 v[108:111], a[232:235], a[252:255], v[108:111]
ds_read_b128 a[220:223], v18 offset:6144
buffer_load_dwordx4 v[152:155], v5, s[56:59], s74 offen offset:2048 sc1
v_mfma_f32_16x16x32_bf16 v[112:115], a[236:239], a[240:243], v[112:115]
ds_read_b64_tr_b16 a[200:201], v26 offset:16384
v_add_u32 v227, 11196, v6
v_mfma_f32_16x16x32_bf16 v[116:119], a[236:239], a[244:247], v[116:119]
ds_read_b64_tr_b16 a[202:203], v26 offset:17408
v_lshl_add_u32 v6, v2, 5, s87
v_mfma_f32_16x16x32_bf16 v[120:123], a[236:239], a[248:251], v[120:123]
ds_read_b64_tr_b16 a[204:205], v27 offset:16384
v_lshl_add_u32 v224, v3, 4, v6
v_mfma_f32_16x16x32_bf16 v[124:127], a[236:239], a[252:255], v[124:127]
ds_read_b64_tr_b16 a[206:207], v27 offset:17408
buffer_load_dwordx4 v[156:159], v5, s[56:59], s74 offen offset:3072 sc1
s_waitcnt lgkmcnt(4)
v_mfma_f32_16x16x32_bf16 v[64:67], a[192:195], a[208:211], v[64:67]
ds_read_b64_tr_b16 a[224:225], v24 offset:24576
v_lshl_add_u32 v228, v3, 3, v6
v_mfma_f32_16x16x32_bf16 v[68:71], a[192:195], a[212:215], v[68:71]
ds_read_b128 a[240:243], v19 offset:0
s_mov_b32 s88, 0x00010001
v_mfma_f32_16x16x32_bf16 v[72:75], a[192:195], a[216:219], v[72:75]
ds_read_b64_tr_b16 a[226:227], v24 offset:25600
s_mov_b32 s89, 0x3f80
v_mfma_f32_16x16x32_bf16 v[76:79], a[192:195], a[220:223], v[76:79]
ds_read_b128 a[244:247], v19 offset:2048
s_add_u32 s77, s84, 4096
buffer_load_dwordx4 a[128:131], v5, s[56:59], s77 offen offset:1024 sc1
v_mfma_f32_16x16x32_bf16 v[80:83], a[196:199], a[208:211], v[80:83]
ds_read_b64_tr_b16 a[228:229], v25 offset:24576
v_lshlrev_b32 v140, 3, v3
v_mfma_f32_16x16x32_bf16 v[84:87], a[196:199], a[212:215], v[84:87]
ds_read_b128 a[248:251], v19 offset:4096
v_add_u32_e64 v6, 11, v2
v_mfma_f32_16x16x32_bf16 v[88:91], a[196:199], a[216:219], v[88:91]
ds_read_b64_tr_b16 a[230:231], v25 offset:25600
v_bfm_b32 v6, 3, v6
v_mfma_f32_16x16x32_bf16 v[92:95], a[196:199], a[220:223], v[92:95]
ds_read_b128 a[252:255], v19 offset:6144
buffer_load_dwordx4 a[132:135], v5, s[56:59], s77 offen offset:2048 sc1
s_waitcnt lgkmcnt(8)
v_mfma_f32_16x16x32_bf16 v[96:99], a[200:203], a[208:211], v[96:99]
ds_read_b64_tr_b16 a[232:233], v26 offset:24576
v_bfe_u32 v6, v6, v140, 8
v_mfma_f32_16x16x32_bf16 v[100:103], a[200:203], a[212:215], v[100:103]
ds_read_b64_tr_b16 a[234:235], v26 offset:25600
v_lshl_or_b32 v6, v6, 15, v6
v_mfma_f32_16x16x32_bf16 v[104:107], a[200:203], a[216:219], v[104:107]
ds_read_b64_tr_b16 a[236:237], v27 offset:24576
v_mov_b32 v248, 163328
ds_write_b32 v248, v58
v_mfma_f32_16x16x32_bf16 v[108:111], a[200:203], a[220:223], v[108:111]
ds_read_b64_tr_b16 a[238:239], v27 offset:25600
s_add_u32 s77, s84, 57344
buffer_load_dwordx4 a[136:139], v5, s[56:59], s77 offen offset:0 sc1
v_mfma_f32_16x16x32_bf16 v[112:115], a[204:207], a[208:211], v[112:115]
s_and_b32 s73, s3, 1
s_lshl1_add_u32 s73, s8, s73
s_lshl_b32 s100, s73, 5
v_mfma_f32_16x16x32_bf16 v[116:119], a[204:207], a[212:215], v[116:119]
s_add_u32 s100, s100, s14
s_lshl_b32 s100, s100, 6
v_mfma_f32_16x16x32_bf16 v[120:123], a[204:207], a[216:219], v[120:123]
s_add_u32 s100, s100, 32768
s_mul_i32 s90, s73, 229376
v_mfma_f32_16x16x32_bf16 v[124:127], a[204:207], a[220:223], v[124:127]
s_lshl_b32 s91, s14, 11
s_add_u32 s90, s90, s91
buffer_load_dwordx4 a[140:143], v5, s[56:59], s77 offen offset:1024 sc1
s_waitcnt lgkmcnt(5)
v_mfma_f32_16x16x32_bf16 v[64:67], a[224:227], a[240:243], v[64:67]
s_add_u32 s90, s90, 10485760
s_lshl_b32 s91, s73, 8
v_mfma_f32_16x16x32_bf16 v[68:71], a[224:227], a[244:247], v[68:71]
v_and_b32 v7, s88, v6
v_mul_u32_u24 v28, s89, v7
v_mfma_f32_16x16x32_bf16 v[72:75], a[224:227], a[248:251], v[72:75]
v_lshrrev_b32 v7, 2, v6
v_and_b32 v7, s88, v7
v_mfma_f32_16x16x32_bf16 v[76:79], a[224:227], a[252:255], v[76:79]
buffer_load_dwordx4 a[144:147], v5, s[56:59], s77 offen offset:2048 sc1
s_waitcnt lgkmcnt(0)
s_waitcnt vmcnt(9)
s_barrier
v_mfma_f32_16x16x32_bf16 v[80:83], a[228:231], a[240:243], v[80:83]
ds_read_b64_tr_b16 a[192:193], v20 offset:16384
v_mul_u32_u24 v29, s89, v7
v_mfma_f32_16x16x32_bf16 v[84:87], a[228:231], a[244:247], v[84:87]
ds_read_b128 a[208:211], v16 offset:0
v_lshrrev_b32_e64 v7, 4, v6
v_mfma_f32_16x16x32_bf16 v[88:91], a[228:231], a[248:251], v[88:91]
ds_read_b64_tr_b16 a[194:195], v20 offset:17408
v_and_b32_e64 v7, s88, v7
v_mfma_f32_16x16x32_bf16 v[92:95], a[228:231], a[252:255], v[92:95]
ds_read_b128 a[212:215], v16 offset:2048
buffer_load_dwordx4 a[148:151], v5, s[56:59], s77 offen offset:3072 sc1
v_mfma_f32_16x16x32_bf16 v[96:99], a[232:235], a[240:243], v[96:99]
ds_read_b64_tr_b16 a[196:197], v21 offset:16384
v_mul_u32_u24_e64 v30, s89, v7
v_mfma_f32_16x16x32_bf16 v[100:103], a[232:235], a[244:247], v[100:103]
ds_read_b128 a[216:219], v16 offset:4096
v_lshrrev_b32_e64 v7, 6, v6
v_mfma_f32_16x16x32_bf16 v[104:107], a[232:235], a[248:251], v[104:107]
ds_read_b64_tr_b16 a[198:199], v21 offset:17408
v_and_b32_e64 v7, s88, v7
v_mfma_f32_16x16x32_bf16 v[108:111], a[232:235], a[252:255], v[108:111]
ds_read_b128 a[220:223], v16 offset:6144
s_add_u32 s77, s84, 61440
buffer_load_dwordx4 a[152:155], v5, s[56:59], s77 offen offset:0 sc1
v_mfma_f32_16x16x32_bf16 v[112:115], a[236:239], a[240:243], v[112:115]
ds_read_b64_tr_b16 a[200:201], v22 offset:16384
v_mul_u32_u24_e64 v31, s89, v7
v_mfma_f32_16x16x32_bf16 v[116:119], a[236:239], a[244:247], v[116:119]
ds_read_b64_tr_b16 a[202:203], v22 offset:17408
v_add_u32_e64 v6, 6, v2
v_mfma_f32_16x16x32_bf16 v[120:123], a[236:239], a[248:251], v[120:123]
ds_read_b64_tr_b16 a[204:205], v23 offset:16384
v_bfm_b32 v6, 5, v6
v_mfma_f32_16x16x32_bf16 v[124:127], a[236:239], a[252:255], v[124:127]
ds_read_b64_tr_b16 a[206:207], v23 offset:17408
buffer_load_dwordx4 a[156:159], v5, s[56:59], s77 offen offset:1024 sc1
s_waitcnt lgkmcnt(4)
v_mfma_f32_16x16x32_bf16 v[64:67], a[192:195], a[208:211], v[64:67]
ds_read_b64_tr_b16 a[224:225], v20 offset:24576
v_bfe_u32 v6, v6, v140, 8
v_mfma_f32_16x16x32_bf16 v[68:71], a[192:195], a[212:215], v[68:71]
ds_read_b128 a[240:243], v17 offset:0
v_lshl_or_b32 v6, v6, 15, v6
v_mfma_f32_16x16x32_bf16 v[72:75], a[192:195], a[216:219], v[72:75]
ds_read_b64_tr_b16 a[226:227], v20 offset:25600
v_and_b32 v7, s88, v6
v_mfma_f32_16x16x32_bf16 v[76:79], a[192:195], a[220:223], v[76:79]
ds_read_b128 a[244:247], v17 offset:2048
buffer_load_dwordx4 a[160:163], v5, s[56:59], s77 offen offset:2048 sc1
v_mfma_f32_16x16x32_bf16 v[80:83], a[196:199], a[208:211], v[80:83]
ds_read_b64_tr_b16 a[228:229], v21 offset:24576
v_mul_u32_u24_e64 v32, s89, v7
v_mfma_f32_16x16x32_bf16 v[84:87], a[196:199], a[212:215], v[84:87]
ds_read_b128 a[248:251], v17 offset:4096
v_lshrrev_b32_e64 v7, 2, v6
v_mfma_f32_16x16x32_bf16 v[88:91], a[196:199], a[216:219], v[88:91]
ds_read_b64_tr_b16 a[230:231], v21 offset:25600
v_and_b32_e64 v7, s88, v7
v_mfma_f32_16x16x32_bf16 v[92:95], a[196:199], a[220:223], v[92:95]
ds_read_b128 a[252:255], v17 offset:6144
s_add_u32 s77, s84, 114688
buffer_load_dwordx4 a[164:167], v5, s[56:59], s77 offen offset:0 sc1
s_waitcnt lgkmcnt(8)
v_mfma_f32_16x16x32_bf16 v[96:99], a[200:203], a[208:211], v[96:99]
ds_read_b64_tr_b16 a[232:233], v22 offset:24576
v_mul_u32_u24 v33, s89, v7
v_mfma_f32_16x16x32_bf16 v[100:103], a[200:203], a[212:215], v[100:103]
ds_read_b64_tr_b16 a[234:235], v22 offset:25600
v_lshrrev_b32_e64 v7, 4, v6
v_mfma_f32_16x16x32_bf16 v[104:107], a[200:203], a[216:219], v[104:107]
ds_read_b64_tr_b16 a[236:237], v23 offset:24576
v_and_b32_e64 v7, s88, v7
v_mfma_f32_16x16x32_bf16 v[108:111], a[200:203], a[220:223], v[108:111]
ds_read_b64_tr_b16 a[238:239], v23 offset:25600
buffer_load_dwordx4 a[168:171], v5, s[56:59], s77 offen offset:1024 sc1
v_mfma_f32_16x16x32_bf16 v[112:115], a[204:207], a[208:211], v[112:115]
v_mul_u32_u24 v34, s89, v7
v_lshrrev_b32 v7, 6, v6
v_mfma_f32_16x16x32_bf16 v[116:119], a[204:207], a[212:215], v[116:119]
v_and_b32 v7, s88, v7
v_mul_u32_u24 v35, s89, v7
v_mfma_f32_16x16x32_bf16 v[120:123], a[204:207], a[216:219], v[120:123]
v_add_u32_e64 v6, 5, v2
v_bfm_b32 v6, 7, v6
v_mfma_f32_16x16x32_bf16 v[124:127], a[204:207], a[220:223], v[124:127]
buffer_load_dwordx4 a[172:175], v5, s[56:59], s77 offen offset:2048 sc1
s_waitcnt lgkmcnt(2)
v_mfma_f32_16x16x32_bf16 v[96:99], a[232:235], a[240:243], v[96:99]
v_bfe_u32 v6, v6, v140, 8
v_lshl_or_b32 v6, v6, 15, v6
v_mfma_f32_16x16x32_bf16 v[100:103], a[232:235], a[244:247], v[100:103]
v_and_b32 v7, s88, v6
v_mul_u32_u24_e64 v36, s89, v7
v_mfma_f32_16x16x32_bf16 v[104:107], a[232:235], a[248:251], v[104:107]
v_lshrrev_b32 v7, 2, v6
v_and_b32 v7, s88, v7
v_mfma_f32_16x16x32_bf16 v[108:111], a[232:235], a[252:255], v[108:111]
buffer_load_dwordx4 a[176:179], v5, s[56:59], s77 offen offset:3072 sc1
s_waitcnt lgkmcnt(0)
s_barrier
v_mfma_f32_16x16x32_bf16 v[112:115], a[236:239], a[240:243], v[112:115]
s_waitcnt vmcnt(13)
ds_write_b128 v48, v[144:147] offset:512
v_mfma_f32_16x16x32_bf16 v[116:119], a[236:239], a[244:247], v[116:119]
v_mul_u32_u24 v37, s89, v7
v_lshrrev_b32_e64 v7, 4, v6
v_mfma_f32_16x16x32_bf16 v[120:123], a[236:239], a[248:251], v[120:123]
v_and_b32 v7, s88, v7
v_mul_u32_u24 v38, s89, v7
v_mfma_f32_16x16x32_bf16 v[124:127], a[236:239], a[252:255], v[124:127]
ds_write_b128 v48, v[148:151] offset:1536
s_add_u32 s77, s84, 118784
buffer_load_dwordx4 a[180:183], v5, s[56:59], s77 offen offset:0 sc1
v_mfma_f32_16x16x32_bf16 v[64:67], a[224:227], a[240:243], v[64:67]
v_lshrrev_b32 v7, 6, v6
v_and_b32 v7, s88, v7
v_mfma_f32_16x16x32_bf16 v[68:71], a[224:227], a[244:247], v[68:71]
v_mul_u32_u24 v39, s89, v7
v_add_u32 v6, 4, v2
v_mfma_f32_16x16x32_bf16 v[72:75], a[224:227], a[248:251], v[72:75]
ds_write_b128 v48, v[152:155] offset:2560
v_bfm_b32 v6, 9, v6
v_mfma_f32_16x16x32_bf16 v[76:79], a[224:227], a[252:255], v[76:79]
v_bfe_u32 v6, v6, v140, 8
v_lshl_or_b32 v6, v6, 15, v6
v_mfma_f32_16x16x32_bf16 v[80:83], a[228:231], a[240:243], v[80:83]
v_and_b32 v7, s88, v6
v_mul_u32_u24 v40, s89, v7
v_mfma_f32_16x16x32_bf16 v[84:87], a[228:231], a[244:247], v[84:87]
ds_write_b128 v48, v[156:159] offset:3584
v_lshrrev_b32_e64 v7, 2, v6
v_mfma_f32_16x16x32_bf16 v[88:91], a[228:231], a[248:251], v[88:91]
v_and_b32 v7, s88, v7
v_mul_u32_u24 v41, s89, v7
v_mfma_f32_16x16x32_bf16 v[92:95], a[228:231], a[252:255], v[92:95]
v_lshrrev_b32 v7, 4, v6
v_and_b32 v7, s88, v7
v_mul_u32_u24 v42, s89, v7
v_lshrrev_b32 v7, 6, v6
v_and_b32 v7, s88, v7
v_mul_u32_u24 v43, s89, v7
s_mov_b32 s89, 0xffff
v_add_u32_e64 v6, 12, v2
v_bfm_b32 v6, 2, v6
v_bfe_u32 v6, v6, v140, 8
v_lshl_or_b32 v6, v6, 15, v6
v_and_b32 v7, s88, v6
v_mul_u32_u24 v44, s89, v7
v_lshrrev_b32 v7, 2, v6
v_and_b32 v7, s88, v7
v_mul_u32_u24 v45, s89, v7
v_lshrrev_b32 v7, 4, v6
v_and_b32 v7, s88, v7
v_mul_u32_u24 v46, s89, v7
v_lshrrev_b32 v7, 6, v6
v_and_b32 v7, s88, v7
v_mul_u32_u24_e64 v47, s89, v7
v_mfma_f32_16x16x32_bf16 v[160:163], a[32:35], a[0:3], 0
v_cvt_pk_bf16_f32 v96, v96, v97
v_cvt_pk_bf16_f32 v97, v98, v99
v_cvt_pk_bf16_f32 v98, v112, v113
v_mfma_f32_16x16x32_bf16 v[164:167], a[64:67], a[0:3], 0
v_cvt_pk_bf16_f32 v99, v114, v115
v_pk_max_i16 v96, v96, 0
v_pk_max_i16 v97, v97, 0
v_mfma_f32_16x16x32_bf16 v[168:171], a[96:99], a[0:3], 0
v_pk_max_i16 v98, v98, 0
v_pk_max_i16 v99, v99, 0
s_add_u32 s75, s90, 0
buffer_store_dwordx4 v[96:99], v5, s[56:59], s75 offen offset:1024 sc1
v_mfma_f32_16x16x32_bf16 v[160:163], a[36:39], a[4:7], v[160:163]
v_cvt_pk_bf16_f32 v100, v100, v101
v_cvt_pk_bf16_f32 v101, v102, v103
v_cvt_pk_bf16_f32 v102, v116, v117
v_mfma_f32_16x16x32_bf16 v[164:167], a[68:71], a[4:7], v[164:167]
v_cvt_pk_bf16_f32 v103, v118, v119
v_pk_max_i16 v100, v100, 0
v_pk_max_i16 v101, v101, 0
v_mfma_f32_16x16x32_bf16 v[168:171], a[100:103], a[4:7], v[168:171]
v_pk_max_i16 v102, v102, 0
v_pk_max_i16 v103, v103, 0
s_add_u32 s75, s90, 57344
buffer_store_dwordx4 v[100:103], v5, s[56:59], s75 offen offset:1024 sc1
v_mfma_f32_16x16x32_bf16 v[160:163], a[40:43], a[8:11], v[160:163]
v_cvt_pk_bf16_f32 v104, v104, v105
v_cvt_pk_bf16_f32 v105, v106, v107
v_cvt_pk_bf16_f32 v106, v120, v121
v_mfma_f32_16x16x32_bf16 v[164:167], a[72:75], a[8:11], v[164:167]
v_cvt_pk_bf16_f32 v107, v122, v123
v_pk_max_i16 v104, v104, 0
v_pk_max_i16 v105, v105, 0
v_mfma_f32_16x16x32_bf16 v[168:171], a[104:107], a[8:11], v[168:171]
v_pk_max_i16 v106, v106, 0
v_pk_max_i16 v107, v107, 0
s_add_u32 s75, s90, 114688
buffer_store_dwordx4 v[104:107], v5, s[56:59], s75 offen offset:1024 sc1
v_mfma_f32_16x16x32_bf16 v[160:163], a[44:47], a[12:15], v[160:163]
v_cvt_pk_bf16_f32 v108, v108, v109
v_cvt_pk_bf16_f32 v109, v110, v111
v_cvt_pk_bf16_f32 v110, v124, v125
v_mfma_f32_16x16x32_bf16 v[164:167], a[76:79], a[12:15], v[164:167]
v_cvt_pk_bf16_f32 v111, v126, v127
v_pk_max_i16 v108, v108, 0
v_pk_max_i16 v109, v109, 0
v_mfma_f32_16x16x32_bf16 v[168:171], a[108:111], a[12:15], v[168:171]
v_pk_max_i16 v110, v110, 0
v_pk_max_i16 v111, v111, 0
s_add_u32 s75, s90, 172032
buffer_store_dwordx4 v[108:111], v5, s[56:59], s75 offen offset:1024 sc1
v_mfma_f32_16x16x32_bf16 v[160:163], a[48:51], a[16:19], v[160:163]
v_cvt_pk_bf16_f32 v64, v64, v65
v_cvt_pk_bf16_f32 v65, v66, v67
v_cvt_pk_bf16_f32 v66, v80, v81
v_mfma_f32_16x16x32_bf16 v[164:167], a[80:83], a[16:19], v[164:167]
v_cvt_pk_bf16_f32 v67, v82, v83
v_pk_max_i16 v64, v64, 0
v_pk_max_i16 v65, v65, 0
v_mfma_f32_16x16x32_bf16 v[168:171], a[112:115], a[16:19], v[168:171]
v_pk_max_i16 v66, v66, 0
v_pk_max_i16 v67, v67, 0
s_add_u32 s75, s90, 0
buffer_store_dwordx4 v[64:67], v5, s[56:59], s75 offen offset:0 sc1
v_mfma_f32_16x16x32_bf16 v[160:163], a[52:55], a[20:23], v[160:163]
v_cvt_pk_bf16_f32 v68, v68, v69
v_cvt_pk_bf16_f32 v69, v70, v71
v_cvt_pk_bf16_f32 v70, v84, v85
v_mfma_f32_16x16x32_bf16 v[164:167], a[84:87], a[20:23], v[164:167]
v_cvt_pk_bf16_f32 v71, v86, v87
v_pk_max_i16 v68, v68, 0
v_pk_max_i16 v69, v69, 0
v_mfma_f32_16x16x32_bf16 v[168:171], a[116:119], a[20:23], v[168:171]
v_pk_max_i16 v70, v70, 0
v_pk_max_i16 v71, v71, 0
s_add_u32 s75, s90, 57344
buffer_store_dwordx4 v[68:71], v5, s[56:59], s75 offen offset:0 sc1
v_mfma_f32_16x16x32_bf16 v[160:163], a[56:59], a[24:27], v[160:163]
v_cvt_pk_bf16_f32 v72, v72, v73
v_cvt_pk_bf16_f32 v73, v74, v75
v_cvt_pk_bf16_f32 v74, v88, v89
v_mfma_f32_16x16x32_bf16 v[164:167], a[88:91], a[24:27], v[164:167]
v_cvt_pk_bf16_f32 v75, v90, v91
v_pk_max_i16 v72, v72, 0
v_pk_max_i16 v73, v73, 0
v_mfma_f32_16x16x32_bf16 v[168:171], a[120:123], a[24:27], v[168:171]
v_pk_max_i16 v74, v74, 0
v_pk_max_i16 v75, v75, 0
s_add_u32 s75, s90, 114688
buffer_store_dwordx4 v[72:75], v5, s[56:59], s75 offen offset:0 sc1
v_mfma_f32_16x16x32_bf16 v[160:163], a[60:63], a[28:31], v[160:163]
v_cvt_pk_bf16_f32 v76, v76, v77
v_cvt_pk_bf16_f32 v77, v78, v79
v_cvt_pk_bf16_f32 v78, v92, v93
v_mfma_f32_16x16x32_bf16 v[164:167], a[92:95], a[28:31], v[164:167]
v_cvt_pk_bf16_f32 v79, v94, v95
v_pk_max_i16 v76, v76, 0
v_pk_max_i16 v77, v77, 0
v_mfma_f32_16x16x32_bf16 v[168:171], a[124:127], a[28:31], v[168:171]
v_pk_max_i16 v78, v78, 0
v_pk_max_i16 v79, v79, 0
s_add_u32 s75, s90, 172032
buffer_store_dwordx4 v[76:79], v5, s[56:59], s75 offen offset:0 sc1
Lpost:
s_cmp_eq_u32 s3, 3
s_cbranch_scc1 Lbeta2
ds_read_b128 v[96:99], v224 offset:480
ds_read_b128 v[100:103], v224 offset:464
ds_read_b128 v[104:107], v224 offset:992
ds_read_b128 v[108:111], v224 offset:976
ds_read_b128 v[112:115], v224 offset:1504
v_cvt_pk_bf16_f32 v176, v167, v167
v_cvt_pk_bf16_f32 v181, v164, v165
v_cvt_pk_bf16_f32 v182, v166, v167
v_readlane_b32 s91, v176, 63
v_cvt_pk_bf16_f32 v172, v163, v162
v_cvt_pk_bf16_f32 v173, v161, v160
v_cvt_pk_bf16_f32 v174, v162, v161
v_and_b32 v44, s91, v44
v_and_b32 v45, s91, v45
v_and_b32 v46, s91, v46
v_and_b32 v47, s91, v47
v_cvt_pk_bf16_f32 v177, v167, v166
v_cvt_pk_bf16_f32 v178, v165, v165
v_cvt_pk_bf16_f32 v179, v165, v164
v_cvt_pk_bf16_f32 v180, v166, v165
v_cvt_pk_bf16_f32 v184, v168, v169
v_cvt_pk_bf16_f32 v185, v170, v171
v_add_f32_e64 v186, s82, v168
v_cvt_pk_bf16_f32 v186, v186, v186
ds_read_b128 v[116:119], v224 offset:1488
ds_read_b128 v[8:11], v224 offset:2016
s_waitcnt lgkmcnt(5)
v_mfma_f32_16x16x32_bf16 v[120:123], v[96:99], v[28:31], 0
ds_write_b64 v51, v[172:173] offset:9784
v_mfma_f32_16x16x32_bf16 v[124:127], v[96:99], v[32:35], 0
ds_write_b32 v51, v174 offset:11004
v_mfma_f32_16x16x32_bf16 v[128:131], v[100:103], v[28:31], 0
ds_write_b16_d16_hi v51, v173 offset:11008
v_mfma_f32_16x16x32_bf16 v[132:135], v[100:103], v[32:35], 0
ds_write_b16 v51, v172 offset:11002
s_nop 2
v_cvt_pk_bf16_f32 v220, v120, v124
v_cvt_pk_bf16_f32 v221, v121, v125
v_mfma_f32_16x16x32_bf16 v[136:139], v[96:99], v[36:39], 0
s_mov_b32 exec_lo, 0xffffffff
s_mov_b32 exec_hi, 0x0
ds_write_b128 v52, v[176:179] offset:10480
ds_write_b16_d16_hi v52, v179 offset:9276
s_mov_b64 exec, -1
v_cvt_pk_bf16_f32 v222, v122, v126
v_cvt_pk_bf16_f32 v223, v123, v127
v_mfma_f32_16x16x32_bf16 v[140:143], v[100:103], v[40:43], 0
s_mov_b32 exec_lo, 0xffffffff
s_mov_b32 exec_hi, 0x0
ds_write_b32 v52, v178 offset:9272
ds_write_b32 v52, v180 offset:9268
s_mov_b64 exec, -1
v_cvt_pk_bf16_f32 v216, v128, v132
v_cvt_pk_bf16_f32 v217, v129, v133
v_mfma_f32_16x16x32_bf16 v[80:83], v[44:47], v[96:99], 0
s_mov_b32 exec_lo, 0xffffffff
s_mov_b32 exec_hi, 0x0
ds_write_b32 v52, v176 offset:9264
ds_write_b16 v52, v176 offset:9262
s_mov_b64 exec, -1
v_cvt_pk_bf16_f32 v218, v130, v134
v_cvt_pk_bf16_f32 v219, v131, v135
ds_read_b128 v[12:15], v224 offset:2000
ds_read_b128 v[96:99], v224 offset:2528
s_waitcnt lgkmcnt(15)
v_mfma_f32_16x16x32_bf16 v[120:123], v[104:107], v[28:31], 0
s_mov_b32 exec_lo, 0x0
s_mov_b32 exec_hi, 0x1
ds_write_b16 v55, v186 offset:9792
ds_write_b16 v55, v186 offset:11010
s_mov_b64 exec, -1
v_cvt_pk_bf16_f32 v212, v136, v140
v_cvt_pk_bf16_f32 v213, v137, v141
v_mfma_f32_16x16x32_bf16 v[124:127], v[104:107], v[32:35], 0
s_mov_b32 exec_lo, 0x0
s_mov_b32 exec_hi, 0x80000000
ds_write_b16 v55, v172 offset:9278
ds_write_b16 v55, v172 offset:10496
s_mov_b64 exec, -1
v_cvt_pk_bf16_f32 v214, v138, v142
v_cvt_pk_bf16_f32 v215, v139, v143
v_mfma_f32_16x16x32_bf16 v[128:131], v[108:111], v[28:31], 0
s_mov_b32 exec_lo, 0x80000000
s_mov_b32 exec_hi, 0x0
ds_write_b16 v55, v176 offset:8764
ds_write_b16 v55, v176 offset:9982
s_mov_b64 exec, -1
v_mfma_f32_16x16x32_bf16 v[132:135], v[108:111], v[32:35], 0
s_mov_b32 exec_lo, 0x0
s_mov_b32 exec_hi, 0xffffffff
ds_write_b32 v53, v181 offset:11452
ds_write_b32 v53, v182 offset:11420
s_mov_b64 exec, -1
v_cvt_pk_bf16_f32 v208, v120, v124
v_cvt_pk_bf16_f32 v209, v121, v125
v_mfma_f32_16x16x32_bf16 v[136:139], v[104:107], v[36:39], 0
s_mov_b32 exec_lo, 0xffffffff
s_mov_b32 exec_hi, 0x0
ds_write_b16 v54, v184 offset:11900
ds_write_b16_d16_hi v54, v184 offset:11868
s_mov_b64 exec, -1
v_cvt_pk_bf16_f32 v210, v122, v126
v_cvt_pk_bf16_f32 v211, v123, v127
v_mfma_f32_16x16x32_bf16 v[140:143], v[108:111], v[40:43], 0
s_mov_b32 exec_lo, 0xffffffff
s_mov_b32 exec_hi, 0x0
ds_write_b16 v54, v185 offset:11836
ds_write_b16_d16_hi v54, v185 offset:11804
s_mov_b64 exec, -1
v_cvt_pk_bf16_f32 v204, v128, v132
v_cvt_pk_bf16_f32 v205, v129, v133
v_mfma_f32_16x16x32_bf16 v[84:87], v[44:47], v[104:107], 0
v_cvt_pk_bf16_f32 v206, v130, v134
v_cvt_pk_bf16_f32 v207, v131, v135
ds_read_b128 v[100:103], v224 offset:2512
ds_read_b128 v[104:107], v224 offset:3040
s_waitcnt lgkmcnt(15)
v_mfma_f32_16x16x32_bf16 v[120:123], v[112:115], v[28:31], 0
ds_read2_b32 a[68:69], v227 offset0:32 offset1:33
ds_read2_b32 a[70:71], v227 offset0:34 offset1:35
v_cvt_pk_bf16_f32 v200, v136, v140
v_cvt_pk_bf16_f32 v201, v137, v141
v_mfma_f32_16x16x32_bf16 v[124:127], v[112:115], v[32:35], 0
ds_read2_b32 a[72:73], v227 offset0:16 offset1:17
ds_read2_b32 a[74:75], v227 offset0:18 offset1:19
v_cvt_pk_bf16_f32 v202, v138, v142
v_cvt_pk_bf16_f32 v203, v139, v143
v_mfma_f32_16x16x32_bf16 v[128:131], v[116:119], v[28:31], 0
ds_read2_b32 a[76:77], v227 offset0:0 offset1:1
ds_read2_b32 a[78:79], v227 offset0:2 offset1:3
v_mfma_f32_16x16x32_bf16 v[132:135], v[116:119], v[32:35], 0
ds_read2_b32 a[80:81], v227 offset0:96 offset1:97
ds_read2_b32 a[82:83], v227 offset0:98 offset1:99
v_cvt_pk_bf16_f32 v196, v120, v124
v_cvt_pk_bf16_f32 v197, v121, v125
v_mfma_f32_16x16x32_bf16 v[136:139], v[112:115], v[36:39], 0
ds_read2_b32 a[84:85], v227 offset0:80 offset1:81
ds_read2_b32 a[86:87], v227 offset0:82 offset1:83
v_cvt_pk_bf16_f32 v198, v122, v126
v_cvt_pk_bf16_f32 v199, v123, v127
v_mfma_f32_16x16x32_bf16 v[140:143], v[116:119], v[40:43], 0
s_waitcnt lgkmcnt(12)
s_barrier
v_cvt_pk_bf16_f32 v192, v128, v132
v_cvt_pk_bf16_f32 v193, v129, v133
v_mfma_f32_16x16x32_bf16 v[88:91], v[44:47], v[112:115], 0
ds_read2_b32 a[88:89], v227 offset0:64 offset1:65
ds_read2_b32 a[90:91], v227 offset0:66 offset1:67
v_cvt_pk_bf16_f32 v194, v130, v134
v_cvt_pk_bf16_f32 v195, v131, v135
ds_read_b128 v[108:111], v224 offset:3024
ds_read_b128 v[112:115], v224 offset:480
v_mfma_f32_16x16x32_bf16 v[120:123], v[8:11], v[28:31], 0
ds_read2_b32 a[92:93], v227 offset0:176 offset1:177
ds_read2_b32 a[94:95], v227 offset0:178 offset1:179
v_cvt_pk_bf16_f32 v188, v136, v140
v_cvt_pk_bf16_f32 v189, v137, v141
v_mfma_f32_16x16x32_bf16 v[124:127], v[8:11], v[32:35], 0
ds_read2_b32 a[96:97], v227 offset0:160 offset1:161
ds_read2_b32 a[98:99], v227 offset0:162 offset1:163
v_cvt_pk_bf16_f32 v190, v138, v142
v_cvt_pk_bf16_f32 v191, v139, v143
v_mfma_f32_16x16x32_bf16 v[128:131], v[12:15], v[28:31], 0
ds_read2_b32 a[100:101], v227 offset0:144 offset1:145
ds_read2_b32 a[102:103], v227 offset0:146 offset1:147
v_mfma_f32_16x16x32_bf16 v[132:135], v[12:15], v[32:35], 0
ds_read2_b32 a[104:105], v227 offset0:128 offset1:129
ds_read2_b32 a[106:107], v227 offset0:130 offset1:131
v_cvt_pk_bf16_f32 v184, v120, v124
v_cvt_pk_bf16_f32 v185, v121, v125
v_mfma_f32_16x16x32_bf16 v[136:139], v[8:11], v[36:39], 0
ds_read2_b32 a[64:65], v225 offset0:1 offset1:2
ds_read2_b32 a[66:67], v225 offset0:3 offset1:4
v_cvt_pk_bf16_f32 v186, v122, v126
v_cvt_pk_bf16_f32 v187, v123, v127
v_mfma_f32_16x16x32_bf16 v[140:143], v[12:15], v[40:43], 0
ds_read2_b32 a[60:61], v225 offset0:17 offset1:18
ds_read2_b32 a[62:63], v225 offset0:19 offset1:20
v_cvt_pk_bf16_f32 v180, v128, v132
v_cvt_pk_bf16_f32 v181, v129, v133
v_mfma_f32_16x16x32_bf16 v[92:95], v[44:47], v[8:11], 0
s_nop 0
ds_read2_b32 a[56:57], v225 offset0:33 offset1:34
ds_read2_b32 a[58:59], v225 offset0:35 offset1:36
v_cvt_pk_bf16_f32 v182, v130, v134
v_cvt_pk_bf16_f32 v183, v131, v135
ds_read_b128 v[116:119], v224 offset:544
ds_read_b128 v[8:11], v224 offset:608
s_waitcnt lgkmcnt(15)
v_mfma_f32_16x16x32_bf16 v[120:123], v[96:99], v[28:31], 0
ds_read2_b32 a[52:53], v225 offset0:49 offset1:50
ds_read2_b32 a[54:55], v225 offset0:51 offset1:52
v_cvt_pk_bf16_f32 v176, v136, v140
v_cvt_pk_bf16_f32 v177, v137, v141
v_mfma_f32_16x16x32_bf16 v[124:127], v[96:99], v[32:35], 0
ds_read2_b32 a[48:49], v225 offset0:65 offset1:66
ds_read2_b32 a[50:51], v225 offset0:67 offset1:68
v_cvt_pk_bf16_f32 v178, v138, v142
v_cvt_pk_bf16_f32 v179, v139, v143
v_mfma_f32_16x16x32_bf16 v[128:131], v[100:103], v[28:31], 0
ds_read2_b32 a[44:45], v225 offset0:81 offset1:82
ds_read2_b32 a[46:47], v225 offset0:83 offset1:84
v_mfma_f32_16x16x32_bf16 v[132:135], v[100:103], v[32:35], 0
ds_read2_b32 a[40:41], v225 offset0:97 offset1:98
ds_read2_b32 a[42:43], v225 offset0:99 offset1:100
v_cvt_pk_bf16_f32 v172, v120, v124
v_cvt_pk_bf16_f32 v173, v121, v125
ds_read_b128 v[12:15], v224 offset:672
ds_read_b128 v[96:99], v224 offset:736
v_mfma_f32_16x16x32_bf16 v[136:139], v[104:107], v[28:31], 0
ds_read2_b32 a[36:37], v225 offset0:113 offset1:114
ds_read2_b32 a[38:39], v225 offset0:115 offset1:116
v_cvt_pk_bf16_f32 v174, v122, v126
v_cvt_pk_bf16_f32 v175, v123, v127
v_mfma_f32_16x16x32_bf16 v[140:143], v[104:107], v[32:35], 0
ds_read2_b32 a[32:33], v225 offset0:129 offset1:130
ds_read2_b32 a[34:35], v225 offset0:131 offset1:132
v_cvt_pk_bf16_f32 v168, v128, v132
v_cvt_pk_bf16_f32 v169, v129, v133
v_mfma_f32_16x16x32_bf16 v[120:123], v[108:111], v[28:31], 0
ds_read2_b32 a[28:29], v225 offset0:145 offset1:146
ds_read2_b32 a[30:31], v225 offset0:147 offset1:148
v_cvt_pk_bf16_f32 v170, v130, v134
v_cvt_pk_bf16_f32 v171, v131, v135
v_mfma_f32_16x16x32_bf16 v[124:127], v[108:111], v[32:35], 0
ds_read2_b32 a[24:25], v225 offset0:161 offset1:162
ds_read2_b32 a[26:27], v225 offset0:163 offset1:164
v_cvt_pk_bf16_f32 v164, v136, v140
v_cvt_pk_bf16_f32 v165, v137, v141
v_mfma_f32_16x16x32_bf16 v[72:75], v[220:223], a[68:71], 0
ds_read2_b32 a[20:21], v225 offset0:177 offset1:178
ds_read2_b32 a[22:23], v225 offset0:179 offset1:180
v_cvt_pk_bf16_f32 v166, v138, v142
v_cvt_pk_bf16_f32 v167, v139, v143
v_mfma_f32_16x16x32_bf16 v[76:79], v[220:223], a[72:75], 0
ds_read2_b32 a[16:17], v225 offset0:193 offset1:194
ds_read2_b32 a[18:19], v225 offset0:195 offset1:196
v_cvt_pk_bf16_f32 v160, v120, v124
v_cvt_pk_bf16_f32 v161, v121, v125
v_mfma_f32_16x16x32_bf16 v[80:83], v[220:223], a[76:79], v[80:83]
ds_read2_b32 a[12:13], v225 offset0:209 offset1:210
ds_read2_b32 a[14:15], v225 offset0:211 offset1:212
v_cvt_pk_bf16_f32 v162, v122, v126
v_cvt_pk_bf16_f32 v163, v123, v127
v_mfma_f32_16x16x32_bf16 v[72:75], v[216:219], a[80:83], v[72:75]
ds_read2_b32 a[8:9], v225 offset0:225 offset1:226
ds_read2_b32 a[10:11], v225 offset0:227 offset1:228
v_mfma_f32_16x16x32_bf16 v[76:79], v[216:219], a[84:87], v[76:79]
ds_read2_b32 a[4:5], v225 offset0:241 offset1:242
ds_read2_b32 a[6:7], v225 offset0:243 offset1:244
v_mfma_f32_16x16x32_bf16 v[80:83], v[216:219], a[88:91], v[80:83]
ds_read2_b32 a[0:1], v226 offset0:129 offset1:130
ds_read2_b32 a[2:3], v226 offset0:131 offset1:132
s_waitcnt lgkmcnt(15)
v_mfma_f32_16x16x32_bf16 v[80:83], v[212:215], a[92:95], v[80:83]
v_mfma_f32_16x16x32_bf16 v[84:87], v[212:215], a[96:99], v[84:87]
v_mfma_f32_16x16x32_bf16 v[88:91], v[212:215], a[100:103], v[88:91]
v_mfma_f32_16x16x32_bf16 v[92:95], v[212:215], a[104:107], v[92:95]
v_mfma_f32_16x16x32_bf16 v[76:79], v[208:211], a[68:71], v[76:79]
v_mfma_f32_16x16x32_bf16 v[80:83], v[208:211], a[72:75], v[80:83]
v_mfma_f32_16x16x32_bf16 v[84:87], v[208:211], a[76:79], v[84:87]
v_mfma_f32_16x16x32_bf16 v[76:79], v[204:207], a[80:83], v[76:79]
s_waitcnt vmcnt(0)
s_mov_b64 exec, 1
buffer_store_dwordx2 v[60:61], off, s[56:59], s100 sc1
s_mov_b64 exec, -1
v_mfma_f32_16x16x32_bf16 v[80:83], v[204:207], a[84:87], v[80:83]
v_mfma_f32_16x16x32_bf16 v[84:87], v[204:207], a[88:91], v[84:87]
v_mfma_f32_16x16x32_bf16 v[84:87], v[200:203], a[92:95], v[84:87]
v_mfma_f32_16x16x32_bf16 v[88:91], v[200:203], a[96:99], v[88:91]
v_mfma_f32_16x16x32_bf16 v[92:95], v[200:203], a[100:103], v[92:95]
v_mfma_f32_16x16x32_bf16 v[80:83], v[196:199], a[68:71], v[80:83]
v_mfma_f32_16x16x32_bf16 v[84:87], v[196:199], a[72:75], v[84:87]
v_mfma_f32_16x16x32_bf16 v[88:91], v[196:199], a[76:79], v[88:91]
v_mfma_f32_16x16x32_bf16 v[80:83], v[192:195], a[80:83], v[80:83]
v_mfma_f32_16x16x32_bf16 v[84:87], v[192:195], a[84:87], v[84:87]
v_mfma_f32_16x16x32_bf16 v[88:91], v[192:195], a[88:91], v[88:91]
v_mfma_f32_16x16x32_bf16 v[88:91], v[188:191], a[92:95], v[88:91]
v_mfma_f32_16x16x32_bf16 v[92:95], v[188:191], a[96:99], v[92:95]
v_mfma_f32_16x16x32_bf16 v[84:87], v[184:187], a[68:71], v[84:87]
v_mfma_f32_16x16x32_bf16 v[88:91], v[184:187], a[72:75], v[88:91]
v_mfma_f32_16x16x32_bf16 v[92:95], v[184:187], a[76:79], v[92:95]
buffer_load_dwordx4 a[184:187], v5, s[56:59], s77 offen offset:1024 sc1
v_mfma_f32_16x16x32_bf16 v[84:87], v[180:183], a[80:83], v[84:87]
v_mfma_f32_16x16x32_bf16 v[88:91], v[180:183], a[84:87], v[88:91]
v_mfma_f32_16x16x32_bf16 v[92:95], v[180:183], a[88:91], v[92:95]
buffer_load_dwordx4 a[188:191], v5, s[56:59], s77 offen offset:2048 sc1
v_mfma_f32_16x16x32_bf16 v[92:95], v[176:179], a[92:95], v[92:95]
v_mfma_f32_16x16x32_bf16 v[88:91], v[172:175], a[68:71], v[88:91]
v_mfma_f32_16x16x32_bf16 v[92:95], v[172:175], a[72:75], v[92:95]
s_add_u32 s77, s84, 172032
buffer_load_dwordx4 a[192:195], v5, s[56:59], s77 offen offset:0 sc1
v_mfma_f32_16x16x32_bf16 v[88:91], v[168:171], a[80:83], v[88:91]
v_mfma_f32_16x16x32_bf16 v[92:95], v[168:171], a[84:87], v[92:95]
v_mfma_f32_16x16x32_bf16 v[92:95], v[164:167], a[68:71], v[92:95]
buffer_load_dwordx4 a[196:199], v5, s[56:59], s77 offen offset:1024 sc1
v_mfma_f32_16x16x32_bf16 v[92:95], v[160:163], a[80:83], v[92:95]
ds_read_b128 v[100:103], v224 offset:800
v_mfma_f32_16x16x32_bf16 v[72:75], a[64:67], v[112:115], v[72:75]
ds_read_b128 v[104:107], v224 offset:864
v_mfma_f32_16x16x32_bf16 v[72:75], a[60:63], v[116:119], v[72:75]
buffer_load_dwordx4 a[200:203], v5, s[56:59], s77 offen offset:2048 sc1
ds_read_b128 v[108:111], v224 offset:928
v_mfma_f32_16x16x32_bf16 v[72:75], a[56:59], v[8:11], v[72:75]
ds_read_b128 v[112:115], v224 offset:992
v_mfma_f32_16x16x32_bf16 v[72:75], a[52:55], v[12:15], v[72:75]
ds_read_b128 v[116:119], v224 offset:1056
s_waitcnt lgkmcnt(4)
v_mfma_f32_16x16x32_bf16 v[72:75], a[48:51], v[96:99], v[72:75]
buffer_load_dwordx4 a[204:207], v5, s[56:59], s77 offen offset:3072 sc1
ds_read_b128 v[8:11], v224 offset:1120
v_mfma_f32_16x16x32_bf16 v[72:75], a[44:47], v[100:103], v[72:75]
ds_read_b128 v[12:15], v224 offset:1184
s_waitcnt lgkmcnt(4)
v_mfma_f32_16x16x32_bf16 v[72:75], a[40:43], v[104:107], v[72:75]
ds_read_b128 v[96:99], v224 offset:1248
v_mfma_f32_16x16x32_bf16 v[72:75], a[36:39], v[108:111], v[72:75]
s_add_u32 s77, s84, 176128
buffer_load_dwordx4 a[208:211], v5, s[56:59], s77 offen offset:0 sc1
ds_read_b128 v[100:103], v224 offset:1312
s_waitcnt lgkmcnt(4)
v_mfma_f32_16x16x32_bf16 v[72:75], a[32:35], v[112:115], v[72:75]
v_mfma_f32_16x16x32_bf16 v[76:79], a[64:67], v[112:115], v[76:79]
ds_read_b128 v[104:107], v224 offset:1376
v_mfma_f32_16x16x32_bf16 v[72:75], a[28:31], v[116:119], v[72:75]
buffer_load_dwordx4 a[212:215], v5, s[56:59], s77 offen offset:1024 sc1
v_mfma_f32_16x16x32_bf16 v[76:79], a[60:63], v[116:119], v[76:79]
ds_read_b128 v[108:111], v224 offset:1440
s_waitcnt lgkmcnt(4)
v_mfma_f32_16x16x32_bf16 v[72:75], a[24:27], v[8:11], v[72:75]
v_mfma_f32_16x16x32_bf16 v[76:79], a[56:59], v[8:11], v[76:79]
buffer_load_dwordx4 a[216:219], v5, s[56:59], s77 offen offset:2048 sc1
ds_read_b128 v[112:115], v224 offset:1504
v_mfma_f32_16x16x32_bf16 v[72:75], a[20:23], v[12:15], v[72:75]
v_mfma_f32_16x16x32_bf16 v[76:79], a[52:55], v[12:15], v[76:79]
ds_read_b128 v[116:119], v224 offset:1568
s_waitcnt lgkmcnt(4)
v_mfma_f32_16x16x32_bf16 v[72:75], a[16:19], v[96:99], v[72:75]
s_add_u32 s77, s84, 229376
buffer_load_dwordx4 a[220:223], v5, s[56:59], s77 offen offset:0 sc1
v_mfma_f32_16x16x32_bf16 v[76:79], a[48:51], v[96:99], v[76:79]
ds_read_b128 v[8:11], v224 offset:1632
v_mfma_f32_16x16x32_bf16 v[72:75], a[12:15], v[100:103], v[72:75]
v_mfma_f32_16x16x32_bf16 v[76:79], a[44:47], v[100:103], v[76:79]
buffer_load_dwordx4 a[224:227], v5, s[56:59], s77 offen offset:1024 sc1
ds_read_b128 v[12:15], v224 offset:1696
s_waitcnt lgkmcnt(4)
v_mfma_f32_16x16x32_bf16 v[72:75], a[8:11], v[104:107], v[72:75]
v_mfma_f32_16x16x32_bf16 v[76:79], a[40:43], v[104:107], v[76:79]
ds_read_b128 v[96:99], v224 offset:1760
v_mfma_f32_16x16x32_bf16 v[72:75], a[4:7], v[108:111], v[72:75]
buffer_load_dwordx4 a[228:231], v5, s[56:59], s77 offen offset:2048 sc1
v_mfma_f32_16x16x32_bf16 v[76:79], a[36:39], v[108:111], v[76:79]
ds_read_b128 v[100:103], v224 offset:1824
s_waitcnt lgkmcnt(4)
v_mfma_f32_16x16x32_bf16 v[72:75], a[0:3], v[112:115], v[72:75]
v_mfma_f32_16x16x32_bf16 v[76:79], a[32:35], v[112:115], v[76:79]
buffer_load_dwordx4 a[232:235], v5, s[56:59], s77 offen offset:3072 sc1
v_mfma_f32_16x16x32_bf16 v[80:83], a[64:67], v[112:115], v[80:83]
ds_read_b128 v[104:107], v224 offset:1888
v_mfma_f32_16x16x32_bf16 v[76:79], a[28:31], v[116:119], v[76:79]
v_mfma_f32_16x16x32_bf16 v[80:83], a[60:63], v[116:119], v[80:83]
s_add_u32 s77, s84, 233472
buffer_load_dwordx4 a[236:239], v5, s[56:59], s77 offen offset:0 sc1
ds_read_b128 v[108:111], v224 offset:1952
s_waitcnt lgkmcnt(4)
v_mfma_f32_16x16x32_bf16 v[76:79], a[24:27], v[8:11], v[76:79]
v_cvt_pk_bf16_f32 v72, v72, v73
v_cvt_pk_bf16_f32 v73, v74, v75
v_mfma_f32_16x16x32_bf16 v[80:83], a[56:59], v[8:11], v[80:83]
ds_write_b64 v228, v[72:73] offset:5632
ds_read_b128 v[112:115], v224 offset:2016
v_mfma_f32_16x16x32_bf16 v[76:79], a[20:23], v[12:15], v[76:79]
buffer_load_dwordx4 a[240:243], v5, s[56:59], s77 offen offset:1024 sc1
v_mfma_f32_16x16x32_bf16 v[80:83], a[52:55], v[12:15], v[80:83]
ds_read_b128 v[116:119], v224 offset:2080
s_waitcnt lgkmcnt(5)
v_mfma_f32_16x16x32_bf16 v[76:79], a[16:19], v[96:99], v[76:79]
v_mfma_f32_16x16x32_bf16 v[80:83], a[48:51], v[96:99], v[80:83]
buffer_load_dwordx4 a[244:247], v5, s[56:59], s77 offen offset:2048 sc1
ds_read_b128 v[8:11], v224 offset:2144
v_mfma_f32_16x16x32_bf16 v[76:79], a[12:15], v[100:103], v[76:79]
v_mfma_f32_16x16x32_bf16 v[80:83], a[44:47], v[100:103], v[80:83]
ds_read_b128 v[12:15], v224 offset:2208
s_waitcnt lgkmcnt(5)
v_mfma_f32_16x16x32_bf16 v[76:79], a[8:11], v[104:107], v[76:79]
s_add_u32 s77, s84, 0
buffer_load_dwordx4 a[108:111], v5, s[56:59], s77 offen offset:0 sc1
v_mfma_f32_16x16x32_bf16 v[80:83], a[40:43], v[104:107], v[80:83]
ds_read_b128 v[96:99], v224 offset:2272
v_mfma_f32_16x16x32_bf16 v[76:79], a[4:7], v[108:111], v[76:79]
v_mfma_f32_16x16x32_bf16 v[80:83], a[36:39], v[108:111], v[80:83]
buffer_load_dwordx4 a[112:115], v5, s[56:59], s77 offen offset:1024 sc1
ds_read_b128 v[100:103], v224 offset:2336
s_waitcnt lgkmcnt(4)
v_mfma_f32_16x16x32_bf16 v[76:79], a[0:3], v[112:115], v[76:79]
v_mfma_f32_16x16x32_bf16 v[80:83], a[32:35], v[112:115], v[80:83]
v_mfma_f32_16x16x32_bf16 v[84:87], a[64:67], v[112:115], v[84:87]
buffer_load_dwordx4 a[116:119], v5, s[56:59], s77 offen offset:2048 sc1
ds_read_b128 v[104:107], v224 offset:2400
v_mfma_f32_16x16x32_bf16 v[80:83], a[28:31], v[116:119], v[80:83]
v_mfma_f32_16x16x32_bf16 v[84:87], a[60:63], v[116:119], v[84:87]
ds_read_b128 v[108:111], v224 offset:2464
s_waitcnt lgkmcnt(4)
v_mfma_f32_16x16x32_bf16 v[80:83], a[24:27], v[8:11], v[80:83]
buffer_load_dwordx4 a[120:123], v5, s[56:59], s77 offen offset:3072 sc1
v_cvt_pk_bf16_f32 v76, v76, v77
v_cvt_pk_bf16_f32 v77, v78, v79
v_mfma_f32_16x16x32_bf16 v[84:87], a[56:59], v[8:11], v[84:87]
ds_write_b64 v228, v[76:77] offset:6144
ds_read_b128 v[112:115], v224 offset:2528
v_mfma_f32_16x16x32_bf16 v[80:83], a[20:23], v[12:15], v[80:83]
v_mfma_f32_16x16x32_bf16 v[84:87], a[52:55], v[12:15], v[84:87]
s_add_u32 s77, s84, 4096
buffer_load_dwordx4 a[124:127], v5, s[56:59], s77 offen offset:0 sc1
ds_read_b128 v[116:119], v224 offset:2592
s_waitcnt lgkmcnt(5)
v_mfma_f32_16x16x32_bf16 v[80:83], a[16:19], v[96:99], v[80:83]
v_mfma_f32_16x16x32_bf16 v[84:87], a[48:51], v[96:99], v[84:87]
buffer_load_dwordx2 v[56:57], v230, s[56:59], 0 offen sc1
ds_read_b128 v[8:11], v224 offset:2656
v_mfma_f32_16x16x32_bf16 v[80:83], a[12:15], v[100:103], v[80:83]
v_mfma_f32_16x16x32_bf16 v[84:87], a[44:47], v[100:103], v[84:87]
ds_read_b128 v[12:15], v224 offset:2720
s_waitcnt lgkmcnt(5)
v_mfma_f32_16x16x32_bf16 v[80:83], a[8:11], v[104:107], v[80:83]
v_mfma_f32_16x16x32_bf16 v[84:87], a[40:43], v[104:107], v[84:87]
ds_read_b128 v[96:99], v224 offset:2784
v_mfma_f32_16x16x32_bf16 v[80:83], a[4:7], v[108:111], v[80:83]
v_mfma_f32_16x16x32_bf16 v[84:87], a[36:39], v[108:111], v[84:87]
ds_read_b128 v[100:103], v224 offset:2848
s_waitcnt lgkmcnt(4)
v_mfma_f32_16x16x32_bf16 v[80:83], a[0:3], v[112:115], v[80:83]
v_mfma_f32_16x16x32_bf16 v[84:87], a[32:35], v[112:115], v[84:87]
v_mfma_f32_16x16x32_bf16 v[88:91], a[64:67], v[112:115], v[88:91]
ds_read_b128 v[104:107], v224 offset:2912
v_mfma_f32_16x16x32_bf16 v[84:87], a[28:31], v[116:119], v[84:87]
v_mfma_f32_16x16x32_bf16 v[88:91], a[60:63], v[116:119], v[88:91]
ds_read_b128 v[108:111], v224 offset:2976
s_waitcnt lgkmcnt(4)
v_mfma_f32_16x16x32_bf16 v[84:87], a[24:27], v[8:11], v[84:87]
v_cvt_pk_bf16_f32 v80, v80, v81
v_cvt_pk_bf16_f32 v81, v82, v83
v_mfma_f32_16x16x32_bf16 v[88:91], a[56:59], v[8:11], v[88:91]
ds_write_b64 v228, v[80:81] offset:6656
ds_read_b128 v[112:115], v224 offset:3040
v_mfma_f32_16x16x32_bf16 v[84:87], a[20:23], v[12:15], v[84:87]
v_mfma_f32_16x16x32_bf16 v[88:91], a[52:55], v[12:15], v[88:91]
ds_read_b128 v[116:119], v224 offset:3104
s_waitcnt lgkmcnt(5)
v_mfma_f32_16x16x32_bf16 v[84:87], a[16:19], v[96:99], v[84:87]
v_mfma_f32_16x16x32_bf16 v[88:91], a[48:51], v[96:99], v[88:91]
ds_read_b128 v[8:11], v224 offset:3168
v_mfma_f32_16x16x32_bf16 v[84:87], a[12:15], v[100:103], v[84:87]
s_waitcnt vmcnt(0)
v_cmp_ne_u64 vcc, s[68:69], v[56:57]
s_nop 0
s_cmp_eq_u64 vcc, 0
s_cselect_b32 s83, 1, 0
v_mfma_f32_16x16x32_bf16 v[88:91], a[44:47], v[100:103], v[88:91]
s_cbranch_vccnz Lnp_8
buffer_load_dwordx4 v[160:163], v5, s[56:59], s18 offen offset:0 sc1
Lnp_8:
ds_read_b128 v[12:15], v224 offset:3232
s_waitcnt lgkmcnt(5)
v_mfma_f32_16x16x32_bf16 v[84:87], a[8:11], v[104:107], v[84:87]
v_mfma_f32_16x16x32_bf16 v[88:91], a[40:43], v[104:107], v[88:91]
s_cbranch_vccnz Lnp_9
buffer_load_dwordx4 v[164:167], v5, s[56:59], s18 offen offset:1024 sc1
Lnp_9:
ds_read_b128 v[96:99], v224 offset:3296
v_mfma_f32_16x16x32_bf16 v[84:87], a[4:7], v[108:111], v[84:87]
v_mfma_f32_16x16x32_bf16 v[88:91], a[36:39], v[108:111], v[88:91]
s_cbranch_vccnz Lnp_10
buffer_load_dwordx4 v[168:171], v5, s[56:59], s18 offen offset:2048 sc1
Lnp_10:
ds_read_b128 v[100:103], v224 offset:3360
s_waitcnt lgkmcnt(4)
v_mfma_f32_16x16x32_bf16 v[84:87], a[0:3], v[112:115], v[84:87]
v_mfma_f32_16x16x32_bf16 v[88:91], a[32:35], v[112:115], v[88:91]
s_cbranch_vccnz Lnp_11
buffer_load_dwordx4 v[172:175], v5, s[56:59], s18 offen offset:3072 sc1
Lnp_11:
v_mfma_f32_16x16x32_bf16 v[92:95], a[64:67], v[112:115], v[92:95]
ds_read_b128 v[104:107], v224 offset:3424
v_mfma_f32_16x16x32_bf16 v[88:91], a[28:31], v[116:119], v[88:91]
s_cbranch_vccnz Lnp_12
s_add_u32 s18, s18, 4096
buffer_load_dwordx4 v[176:179], v5, s[56:59], s18 offen offset:0 sc1
Lnp_12:
v_mfma_f32_16x16x32_bf16 v[92:95], a[60:63], v[116:119], v[92:95]
ds_read_b128 v[108:111], v224 offset:3488
s_waitcnt lgkmcnt(4)
v_mfma_f32_16x16x32_bf16 v[88:91], a[24:27], v[8:11], v[88:91]
s_cbranch_vccnz Lnp_13
buffer_load_dwordx4 v[180:183], v5, s[56:59], s18 offen offset:1024 sc1
Lnp_13:
v_cvt_pk_bf16_f32 v84, v84, v85
v_cvt_pk_bf16_f32 v85, v86, v87
v_mfma_f32_16x16x32_bf16 v[92:95], a[56:59], v[8:11], v[92:95]
ds_write_b64 v228, v[84:85] offset:7168
ds_read_b128 v[112:115], v224 offset:3552
v_mfma_f32_16x16x32_bf16 v[88:91], a[20:23], v[12:15], v[88:91]
s_cbranch_vccnz Lnp_14
buffer_load_dwordx4 v[184:187], v5, s[56:59], s18 offen offset:2048 sc1
Lnp_14:
v_mfma_f32_16x16x32_bf16 v[92:95], a[52:55], v[12:15], v[92:95]
ds_read_b128 v[116:119], v224 offset:3616
s_waitcnt lgkmcnt(5)
v_mfma_f32_16x16x32_bf16 v[88:91], a[16:19], v[96:99], v[88:91]
s_cbranch_vccnz Lnp_15
buffer_load_dwordx4 v[188:191], v5, s[56:59], s19 offen offset:0 sc1
Lnp_15:
v_mfma_f32_16x16x32_bf16 v[92:95], a[48:51], v[96:99], v[92:95]
ds_read_b128 v[8:11], v224 offset:3680
v_mfma_f32_16x16x32_bf16 v[88:91], a[12:15], v[100:103], v[88:91]
s_cbranch_vccnz Lnp_16
buffer_load_dwordx4 v[192:195], v5, s[56:59], s19 offen offset:1024 sc1
Lnp_16:
v_mfma_f32_16x16x32_bf16 v[92:95], a[44:47], v[100:103], v[92:95]
ds_read_b128 v[12:15], v224 offset:3744
s_waitcnt lgkmcnt(5)
v_mfma_f32_16x16x32_bf16 v[88:91], a[8:11], v[104:107], v[88:91]
s_cbranch_vccnz Lnp_17
buffer_load_dwordx4 v[196:199], v5, s[56:59], s19 offen offset:2048 sc1
Lnp_17:
v_mfma_f32_16x16x32_bf16 v[92:95], a[40:43], v[104:107], v[92:95]
ds_read_b128 v[96:99], v224 offset:3808
v_mfma_f32_16x16x32_bf16 v[88:91], a[4:7], v[108:111], v[88:91]
s_cbranch_vccnz Lnp_18
buffer_load_dwordx4 v[200:203], v5, s[56:59], s19 offen offset:3072 sc1
Lnp_18:
v_mfma_f32_16x16x32_bf16 v[92:95], a[36:39], v[108:111], v[92:95]
ds_read_b128 v[100:103], v224 offset:3872
s_waitcnt lgkmcnt(4)
v_mfma_f32_16x16x32_bf16 v[88:91], a[0:3], v[112:115], v[88:91]
s_cbranch_vccnz Lnp_19
s_add_u32 s19, s19, 4096
buffer_load_dwordx4 v[204:207], v5, s[56:59], s19 offen offset:0 sc1
Lnp_19:
v_mfma_f32_16x16x32_bf16 v[92:95], a[32:35], v[112:115], v[92:95]
ds_read_b128 v[104:107], v224 offset:3936
v_mfma_f32_16x16x32_bf16 v[92:95], a[28:31], v[116:119], v[92:95]
s_cbranch_vccnz Lnp_20
buffer_load_dwordx4 v[208:211], v5, s[56:59], s19 offen offset:1024 sc1
Lnp_20:
ds_read_b128 v[108:111], v224 offset:4000
s_waitcnt lgkmcnt(4)
v_mfma_f32_16x16x32_bf16 v[92:95], a[24:27], v[8:11], v[92:95]
ds_read_b128 v[112:115], v224 offset:4064
v_mfma_f32_16x16x32_bf16 v[92:95], a[20:23], v[12:15], v[92:95]
s_cbranch_vccnz Lnp_21
buffer_load_dwordx4 v[212:215], v5, s[56:59], s19 offen offset:2048 sc1
Lnp_21:
v_cvt_pk_bf16_f32 v88, v88, v89
v_cvt_pk_bf16_f32 v89, v90, v91
s_waitcnt lgkmcnt(3)
v_mfma_f32_16x16x32_bf16 v[92:95], a[16:19], v[96:99], v[92:95]
ds_write_b64 v228, v[88:89] offset:7680
v_mfma_f32_16x16x32_bf16 v[92:95], a[12:15], v[100:103], v[92:95]
s_cbranch_vccnz Lnp_22
buffer_load_dwordx4 v[216:219], v5, s[56:59], s20 offen offset:0 sc1
Lnp_22:
s_waitcnt lgkmcnt(2)
v_mfma_f32_16x16x32_bf16 v[92:95], a[8:11], v[104:107], v[92:95]
v_mfma_f32_16x16x32_bf16 v[92:95], a[4:7], v[108:111], v[92:95]
s_waitcnt lgkmcnt(1)
v_mfma_f32_16x16x32_bf16 v[92:95], a[0:3], v[112:115], v[92:95]
s_nop 7
v_cvt_pk_bf16_f32 v92, v92, v93
v_cvt_pk_bf16_f32 v93, v94, v95
ds_write_b64 v228, v[92:93] offset:8192
s_mov_b32 s66, s15
s_mul_i32 s90, s80, 4224
s_add_u32 s90, s90, 4194304
s_mov_b32 s86, 0
Lbw:
ds_read_b32 v6, v248
s_waitcnt lgkmcnt(0)
v_cmp_lt_u32 vcc, s3, v6
s_cbranch_vccnz Lbwd
s_add_u32 s86, s86, 1
s_cmp_gt_u32 s86, 1280000
s_cbranch_scc1 Lbwd
s_branch Lbw
Lbwd:
ds_read_b128 v[144:147], v48 offset:4608
ds_read_b128 v[148:151], v48 offset:5632
ds_read_b128 v[152:155], v48 offset:6656
ds_read_b128 v[156:159], v48 offset:7680
s_lshl_b32 s100, s80, 6
s_add_u32 s100, s100, 131072
s_waitcnt lgkmcnt(3)
buffer_store_dwordx4 v[144:147], v5, s[64:67], s90 offen offset:0 sc1
s_waitcnt lgkmcnt(2)
buffer_store_dwordx4 v[148:151], v5, s[64:67], s90 offen offset:1024 sc1
s_waitcnt lgkmcnt(1)
buffer_store_dwordx4 v[152:155], v5, s[64:67], s90 offen offset:2048 sc1
s_waitcnt lgkmcnt(0)
buffer_store_dwordx4 v[156:159], v5, s[64:67], s90 offen offset:3072 sc1
s_cmp_lg_u32 s83, 0
s_cbranch_scc1 Lg2b
v_cmp_ne_u64 vcc, s[68:69], v[56:57]
s_cbranch_vccnz Lsp_23
Lsd_24:
s_branch Lg2
Lbeta2:
buffer_load_dwordx4 a[184:187], v5, s[56:59], s77 offen offset:1024 sc1
buffer_load_dwordx4 a[188:191], v5, s[56:59], s77 offen offset:2048 sc1
s_add_u32 s77, s84, 172032
buffer_load_dwordx4 a[192:195], v5, s[56:59], s77 offen offset:0 sc1
buffer_load_dwordx4 a[196:199], v5, s[56:59], s77 offen offset:1024 sc1
buffer_load_dwordx4 a[200:203], v5, s[56:59], s77 offen offset:2048 sc1
buffer_load_dwordx4 a[204:207], v5, s[56:59], s77 offen offset:3072 sc1
s_mov_b32 s66, 0
s_mov_b32 s85, 0
s_barrier
Lbc:
s_nop 0
ds_read_b128 v[96:99], v224 offset:32
ds_read_b128 v[100:103], v224 offset:96
ds_read2_b32 a[28:29], v225 offset0:145 offset1:146
ds_read2_b32 a[30:31], v225 offset0:147 offset1:148
ds_read2_b32 a[60:61], v225 offset0:17 offset1:18
ds_read2_b32 a[62:63], v225 offset0:19 offset1:20
ds_read2_b32 a[24:25], v225 offset0:161 offset1:162
ds_read2_b32 a[26:27], v225 offset0:163 offset1:164
ds_read2_b32 a[56:57], v225 offset0:33 offset1:34
ds_read2_b32 a[58:59], v225 offset0:35 offset1:36
ds_read_b128 v[104:107], v224 offset:160
ds_read_b128 v[108:111], v224 offset:224
ds_read_b128 v[112:115], v224 offset:288
ds_read_b128 v[116:119], v224 offset:352
ds_read_b128 v[8:11], v224 offset:416
s_waitcnt lgkmcnt(13)
s_waitcnt lgkmcnt(11)
v_mfma_f32_16x16x32_bf16 v[64:67], a[28:31], v[96:99], 0
ds_read2_b32 a[20:21], v225 offset0:177 offset1:178
ds_read2_b32 a[22:23], v225 offset0:179 offset1:180
s_waitcnt lgkmcnt(11)
v_mfma_f32_16x16x32_bf16 v[68:71], a[60:63], v[96:99], 0
ds_read2_b32 a[52:53], v225 offset0:49 offset1:50
ds_read2_b32 a[54:55], v225 offset0:51 offset1:52
ds_read_b128 v[12:15], v224 offset:480
s_waitcnt lgkmcnt(12)
v_mfma_f32_16x16x32_bf16 v[64:67], a[24:27], v[100:103], v[64:67]
ds_read2_b32 a[16:17], v225 offset0:193 offset1:194
ds_read2_b32 a[18:19], v225 offset0:195 offset1:196
s_waitcnt lgkmcnt(12)
v_mfma_f32_16x16x32_bf16 v[68:71], a[56:59], v[100:103], v[68:71]
ds_read2_b32 a[48:49], v225 offset0:65 offset1:66
ds_read2_b32 a[50:51], v225 offset0:67 offset1:68
ds_read_b128 v[96:99], v224 offset:544
s_waitcnt lgkmcnt(13)
s_waitcnt lgkmcnt(8)
v_mfma_f32_16x16x32_bf16 v[64:67], a[20:23], v[104:107], v[64:67]
ds_read2_b32 a[12:13], v225 offset0:209 offset1:210
ds_read2_b32 a[14:15], v225 offset0:211 offset1:212
s_waitcnt lgkmcnt(8)
v_mfma_f32_16x16x32_bf16 v[68:71], a[52:55], v[104:107], v[68:71]
ds_read2_b32 a[44:45], v225 offset0:81 offset1:82
ds_read2_b32 a[46:47], v225 offset0:83 offset1:84
ds_read_b128 v[100:103], v224 offset:608
s_waitcnt lgkmcnt(8)
v_mfma_f32_16x16x32_bf16 v[64:67], a[16:19], v[108:111], v[64:67]
ds_read2_b32 a[8:9], v225 offset0:225 offset1:226
ds_read2_b32 a[10:11], v225 offset0:227 offset1:228
s_waitcnt lgkmcnt(8)
v_mfma_f32_16x16x32_bf16 v[68:71], a[48:51], v[108:111], v[68:71]
ds_read2_b32 a[40:41], v225 offset0:97 offset1:98
ds_read2_b32 a[42:43], v225 offset0:99 offset1:100
ds_read_b128 v[104:107], v224 offset:672
s_waitcnt lgkmcnt(8)
v_mfma_f32_16x16x32_bf16 v[64:67], a[12:15], v[112:115], v[64:67]
ds_read2_b32 a[4:5], v225 offset0:241 offset1:242
ds_read2_b32 a[6:7], v225 offset0:243 offset1:244
s_waitcnt lgkmcnt(8)
v_mfma_f32_16x16x32_bf16 v[68:71], a[44:47], v[112:115], v[68:71]
ds_read2_b32 a[36:37], v225 offset0:113 offset1:114
ds_read2_b32 a[38:39], v225 offset0:115 offset1:116
ds_read_b128 v[108:111], v224 offset:736
s_waitcnt lgkmcnt(8)
v_mfma_f32_16x16x32_bf16 v[64:67], a[8:11], v[116:119], v[64:67]
ds_read2_b32 a[0:1], v226 offset0:129 offset1:130
ds_read2_b32 a[2:3], v226 offset0:131 offset1:132
s_waitcnt lgkmcnt(8)
v_mfma_f32_16x16x32_bf16 v[68:71], a[40:43], v[116:119], v[68:71]
ds_read2_b32 a[32:33], v225 offset0:129 offset1:130
ds_read2_b32 a[34:35], v225 offset0:131 offset1:132
ds_read_b128 v[112:115], v224 offset:800
s_waitcnt lgkmcnt(8)
v_mfma_f32_16x16x32_bf16 v[64:67], a[4:7], v[8:11], v[64:67]
s_waitcnt lgkmcnt(6)
v_mfma_f32_16x16x32_bf16 v[68:71], a[36:39], v[8:11], v[68:71]
ds_read_b128 v[116:119], v224 offset:864
s_waitcnt lgkmcnt(4)
v_mfma_f32_16x16x32_bf16 v[64:67], a[0:3], v[12:15], v[64:67]
s_waitcnt lgkmcnt(2)
v_mfma_f32_16x16x32_bf16 v[68:71], a[32:35], v[12:15], v[68:71]
ds_read_b128 v[8:11], v224 offset:928
v_mfma_f32_16x16x32_bf16 v[68:71], a[28:31], v[96:99], v[68:71]
ds_read_b128 v[12:15], v224 offset:992
v_mfma_f32_16x16x32_bf16 v[68:71], a[24:27], v[100:103], v[68:71]
v_mfma_f32_16x16x32_bf16 v[68:71], a[20:23], v[104:107], v[68:71]
s_nop 0
v_cvt_pk_bf16_f32 v64, v64, v65
v_cvt_pk_bf16_f32 v65, v66, v67
ds_write_b64 v228, v[64:65] offset:4608
v_mfma_f32_16x16x32_bf16 v[68:71], a[16:19], v[108:111], v[68:71]
s_waitcnt lgkmcnt(3)
v_mfma_f32_16x16x32_bf16 v[68:71], a[12:15], v[112:115], v[68:71]
v_mfma_f32_16x16x32_bf16 v[68:71], a[8:11], v[116:119], v[68:71]
s_waitcnt lgkmcnt(1)
v_mfma_f32_16x16x32_bf16 v[68:71], a[4:7], v[8:11], v[68:71]
v_mfma_f32_16x16x32_bf16 v[68:71], a[0:3], v[12:15], v[68:71]
s_nop 7
v_cvt_pk_bf16_f32 v68, v68, v69
v_cvt_pk_bf16_f32 v69, v70, v71
ds_write_b64 v228, v[68:69] offset:5120
s_add_u32 s85, s85, 1
v_mov_b32 v6, s85
ds_write_b32 v248, v6
v_add_u32 v224, 12288, v224
v_add_u32 v225, 12288, v225
v_add_u32 v226, 12288, v226
v_add_u32 v227, 12288, v227
v_add_u32 v228, 12288, v228
s_cmp_lg_u32 s85, 1
s_cbranch_scc1 Lbnf
s_waitcnt vmcnt(6)
s_mov_b64 exec, 1
buffer_store_dwordx2 v[60:61], off, s[56:59], s100 sc1
s_mov_b64 exec, -1
Lbnf:
s_cmp_lt_u32 s85, 3
s_cbranch_scc1 Lbc
s_nop 0
s_add_u32 s77, s84, 176128
buffer_load_dwordx4 a[208:211], v5, s[56:59], s77 offen offset:0 sc1
buffer_load_dwordx4 a[212:215], v5, s[56:59], s77 offen offset:1024 sc1
buffer_load_dwordx4 a[216:219], v5, s[56:59], s77 offen offset:2048 sc1
s_add_u32 s77, s84, 229376
buffer_load_dwordx4 a[220:223], v5, s[56:59], s77 offen offset:0 sc1
buffer_load_dwordx4 a[224:227], v5, s[56:59], s77 offen offset:1024 sc1
buffer_load_dwordx4 a[228:231], v5, s[56:59], s77 offen offset:2048 sc1
buffer_load_dwordx4 a[232:235], v5, s[56:59], s77 offen offset:3072 sc1
s_add_u32 s77, s84, 233472
buffer_load_dwordx4 a[236:239], v5, s[56:59], s77 offen offset:0 sc1
buffer_load_dwordx4 a[240:243], v5, s[56:59], s77 offen offset:1024 sc1
buffer_load_dwordx4 a[244:247], v5, s[56:59], s77 offen offset:2048 sc1
s_add_u32 s77, s84, 0
s_nop 0
buffer_load_dwordx4 a[108:111], v5, s[56:59], s77 offen offset:0 sc1
buffer_load_dwordx4 a[112:115], v5, s[56:59], s77 offen offset:1024 sc1
buffer_load_dwordx4 a[116:119], v5, s[56:59], s77 offen offset:2048 sc1
buffer_load_dwordx4 a[120:123], v5, s[56:59], s77 offen offset:3072 sc1
s_add_u32 s77, s84, 4096
buffer_load_dwordx4 a[124:127], v5, s[56:59], s77 offen offset:0 sc1
buffer_load_dwordx2 v[56:57], v230, s[56:59], 0 offen sc1
s_waitcnt vmcnt(0)
v_cmp_ne_u64_e64 vcc, s[68:69], v[56:57]
s_cbranch_vccnz Lsp_25
Lsd_26:
s_branch Lg2
Lg1gate:
s_lshl_b32 s86, s13, 7
s_add_u32 s86, s86, 160512
v_lshl_add_u32 v59, v3, 4, s86
s_add_u32 s13, s13, 1
s_cmp_eq_u32 s13, 10
s_cselect_b32 s13, 0, s13
s_nop 0
ds_read_b128 a[192:195], v59 offset:0
ds_read_b128 a[208:211], v16 offset:0
ds_read_b128 a[212:215], v16 offset:2048
ds_read_b128 a[216:219], v16 offset:4096
ds_read_b128 a[220:223], v16 offset:6144
s_waitcnt lgkmcnt(0)
v_mfma_f32_16x16x32_bf16 v[64:67], a[192:195], a[208:211], 0
ds_read_b128 a[224:227], v59 offset:64
s_lshr_b32 s73, s101, 1
v_mfma_f32_16x16x32_bf16 v[68:71], a[192:195], a[212:215], 0
ds_read_b128 a[240:243], v17 offset:0
s_add_u32 m0, s72, 81920
v_mfma_f32_16x16x32_bf16 v[72:75], a[192:195], a[216:219], 0
ds_read_b128 a[244:247], v17 offset:2048
buffer_load_dwordx4 v12, s[52:55], s71 offen offset:0 lds
v_mfma_f32_16x16x32_bf16 v[76:79], a[192:195], a[220:223], 0
ds_read_b128 a[248:251], v17 offset:4096
v_bfe_u32 v6, v1, 1, 2
ds_read_b128 a[252:255], v17 offset:6144
v_add_u32 v6, s73, v6
v_mul_u32_u24_e64 v6, 5, v6
s_mul_i32 s74, s11, 5
buffer_load_dwordx4 v13, s[52:55], s71 offen offset:1024 lds
v_and_b32_e64 v7, 1, v1
v_lshl_add_u32 v7, v7, 2, s74
s_add_u32 s12, s12, 1
s_cmp_eq_u32 s12, 10
s_cselect_b32 s78, 9, -1
s_mul_i32 s79, s78, 128
s_sub_u32 s70, s70, s79
buffer_load_dwordx4 v14, s[52:55], s71 offen offset:2048 lds
v_lshrrev_b32_e64 v7, 3, v7
s_cmp_eq_u32 s12, 10
s_cselect_b32 s12, 0, s12
v_add_lshl_u32 v6, v6, v7, 6
v_add_u32 v229, 16384, v6
s_lshr_b32 s74, s80, 6
s_lshl_b32 s74, s74, 10
buffer_load_dwordx4 v15, s[52:55], s71 offen offset:3072 lds
s_add_u32 s74, s74, 4096
s_mul_i32 s79, s78, 221184
s_sub_u32 s71, s71, s79
s_waitcnt lgkmcnt(0)
v_mfma_f32_16x16x32_bf16 v[64:67], a[224:227], a[240:243], v[64:67]
v_lshl_add_u32 v6, v2, 6, s74
v_cmp_lt_u32 vcc, 31, v1
s_nop 1
v_cndmask_b32_e64 v229, v229, v6, vcc
v_mfma_f32_16x16x32_bf16 v[68:71], a[224:227], a[244:247], v[68:71]
v_and_b32 v6, 3, v1
v_add_u32 v6, s73, v6
v_mfma_f32_16x16x32_bf16 v[72:75], a[224:227], a[248:251], v[72:75]
v_and_b32_e64 v7, 4, v1
v_lshl_add_u32 v6, v7, 3, v6
v_mfma_f32_16x16x32_bf16 v[76:79], a[224:227], a[252:255], v[76:79]
v_cmp_gt_u32 vcc, 8, v1
s_lshl_b32 s73, s10, 5
s_nop 0
v_cndmask_b32_e64 v6, 27, v6, vcc
s_waitcnt vmcnt(36)
s_barrier
s_lshl_b32 s86, s13, 7
s_add_u32 s86, s86, 160512
v_lshl_add_u32 v59, v3, 4, s86
s_add_u32 s13, s13, 1
s_cmp_eq_u32 s13, 10
s_cselect_b32 s13, 0, s13
ds_read_b128 a[192:195], v59 offset:0
ds_read_b128 a[208:211], v16 offset:32768
s_add_u32 m0, s72, 0
ds_read_b128 a[212:215], v16 offset:34816
buffer_load_dwordx4 v8, s[48:51], s70 offen offset:0 lds
ds_read_b128 a[216:219], v16 offset:36864
ds_read_b128 a[220:223], v16 offset:38912
v_xor_b32 v6, s73, v6
v_lshlrev_b32 v6, 6, v6
v_add_u32 v230, 32768, v6
buffer_load_dwordx4 v9, s[48:51], s70 offen offset:1024 lds
s_lshl_b32 s74, s101, 10
s_add_u32 s74, s74, 10485760
s_add_u32 s73, s93, 1
s_and_b32 s73, s73, 3
s_lshl2_add_u32 s22, s10, s73
s_xor_b32 s18, s22, 4
s_mul_i32 s18, s18, 57344
buffer_load_dwordx4 v10, s[48:51], s70 offen offset:2048 lds
s_add_u32 s18, s18, s74
s_mul_i32 s22, s22, 57344
s_waitcnt lgkmcnt(0)
v_mfma_f32_16x16x32_bf16 v[64:67], a[192:195], a[208:211], v[64:67]
ds_read_b128 a[224:227], v59 offset:64
s_add_u32 s22, s22, s74
v_mfma_f32_16x16x32_bf16 v[68:71], a[192:195], a[212:215], v[68:71]
ds_read_b128 a[240:243], v17 offset:32768
s_mul_i32 s73, s73, 15360
v_mfma_f32_16x16x32_bf16 v[72:75], a[192:195], a[216:219], v[72:75]
ds_read_b128 a[244:247], v17 offset:34816
buffer_load_dwordx4 v11, s[48:51], s70 offen offset:3072 lds
v_mfma_f32_16x16x32_bf16 v[76:79], a[192:195], a[220:223], v[76:79]
ds_read_b128 a[248:251], v17 offset:36864
v_add_u32_e64 v231, s73, v5
ds_read_b128 a[252:255], v17 offset:38912
s_add_u32 s73, s93, 2
s_add_u32 m0, s72, 16384
s_and_b32 s73, s73, 3
buffer_load_dwordx4 v12, s[52:55], s71 offen offset:0 lds
s_lshl2_add_u32 s23, s10, s73
s_xor_b32 s19, s23, 4
s_mul_i32 s19, s19, 57344
s_add_u32 s19, s19, s74
s_mul_i32 s23, s23, 57344
s_add_u32 s23, s23, s74
buffer_load_dwordx4 v13, s[52:55], s71 offen offset:1024 lds
s_mul_i32 s73, s73, 15360
v_add_u32_e64 v232, s73, v5
s_add_u32 s73, s93, 3
s_add_u32 s12, s12, 1
s_cmp_eq_u32 s12, 10
s_cselect_b32 s78, 9, -1
s_mul_i32 s79, s78, 128
s_sub_u32 s70, s70, s79
buffer_load_dwordx4 v14, s[52:55], s71 offen offset:2048 lds
s_and_b32 s73, s73, 3
s_cmp_eq_u32 s12, 10
s_cselect_b32 s12, 0, s12
s_waitcnt lgkmcnt(0)
v_mfma_f32_16x16x32_bf16 v[64:67], a[224:227], a[240:243], v[64:67]
s_lshl2_add_u32 s24, s10, s73
s_xor_b32 s20, s24, 4
v_mfma_f32_16x16x32_bf16 v[68:71], a[224:227], a[244:247], v[68:71]
s_mul_i32 s20, s20, 57344
s_add_u32 s20, s20, s74
v_mfma_f32_16x16x32_bf16 v[72:75], a[224:227], a[248:251], v[72:75]
buffer_load_dwordx4 v15, s[52:55], s71 offen offset:3072 lds
s_mul_i32 s24, s24, 57344
v_mfma_f32_16x16x32_bf16 v[76:79], a[224:227], a[252:255], v[76:79]
s_mul_i32 s79, s78, 221184
s_sub_u32 s71, s71, s79
s_waitcnt vmcnt(8)
s_barrier
s_mov_b64 exec, 1
buffer_store_dwordx2 v[60:61], off, s[64:67], s83 sc1
s_mov_b64 exec, -1
s_lshl_b32 s86, s13, 7
s_add_u32 s86, s86, 160512
v_lshl_add_u32 v59, v3, 4, s86
s_add_u32 s13, s13, 1
s_cmp_eq_u32 s13, 10
s_cselect_b32 s13, 0, s13
s_nop 0
ds_read_b128 a[192:195], v59 offset:0
ds_read_b128 a[208:211], v18 offset:0
s_add_u32 m0, s72, 32768
ds_read_b128 a[212:215], v18 offset:2048
buffer_load_dwordx4 v8, s[48:51], s70 offen offset:0 lds
ds_read_b128 a[216:219], v18 offset:4096
ds_read_b128 a[220:223], v18 offset:6144
s_add_u32 s24, s24, s74
s_mul_i32 s73, s73, 15360
v_add_u32 v233, s73, v5
buffer_load_dwordx4 v9, s[48:51], s70 offen offset:1024 lds
s_add_u32 s73, s93, 4
s_and_b32 s73, s73, 3
s_lshl2_add_u32 s25, s10, s73
s_xor_b32 s21, s25, 4
s_mul_i32 s21, s21, 57344
s_add_u32 s21, s21, s74
s_mul_i32 s25, s25, 57344
buffer_load_dwordx4 v10, s[48:51], s70 offen offset:2048 lds
s_add_u32 s25, s25, s74
s_mul_i32 s73, s73, 15360
s_waitcnt lgkmcnt(0)
v_mfma_f32_16x16x32_bf16 v[64:67], a[192:195], a[208:211], v[64:67]
ds_read_b128 a[224:227], v59 offset:64
v_add_u32 v234, s73, v5
v_mfma_f32_16x16x32_bf16 v[68:71], a[192:195], a[212:215], v[68:71]
ds_read_b128 a[240:243], v19 offset:0
s_mul_i32 s26, s11, 80
v_mfma_f32_16x16x32_bf16 v[72:75], a[192:195], a[216:219], v[72:75]
ds_read_b128 a[244:247], v19 offset:2048
buffer_load_dwordx4 v11, s[48:51], s70 offen offset:3072 lds
v_mfma_f32_16x16x32_bf16 v[76:79], a[192:195], a[220:223], v[76:79]
ds_read_b128 a[248:251], v19 offset:4096
s_mul_i32 s74, s3, 20
ds_read_b128 a[252:255], v19 offset:6144
s_add_u32 s26, s26, s74
s_add_u32 m0, s72, 49152
v_add_lshl_u32 v6, v1, s26, 6
buffer_load_dwordx4 v12, s[52:55], s71 offen offset:0 lds
v_add_u32 v6, 131072, v6
s_lshl2_add_u32 s29, s2, s3
s_xor_b32 s34, s29, 4
s_lshl_b32 s35, s34, 6
s_add_u32 s35, s35, 262144
v_mov_b32 v7, s35
buffer_load_dwordx4 v13, s[52:55], s71 offen offset:1024 lds
v_cmp_lt_u32_e64 vcc, 19, v1
s_xor_b32 s35, s35, 256
s_mul_i32 s29, s29, 2560
v_cndmask_b32_e64 v235, v6, v7, vcc
s_add_u32 s29, s29, 17825792
s_mul_i32 s34, s34, 2560
s_add_u32 s12, s12, 1
s_cmp_eq_u32 s12, 10
s_cselect_b32 s78, 9, -1
s_mul_i32 s79, s78, 128
s_sub_u32 s70, s70, s79
buffer_load_dwordx4 v14, s[52:55], s71 offen offset:2048 lds
s_add_u32 s34, s34, 17825792
s_cmp_eq_u32 s12, 10
s_cselect_b32 s12, 0, s12
s_waitcnt lgkmcnt(0)
v_mfma_f32_16x16x32_bf16 v[64:67], a[224:227], a[240:243], v[64:67]
v_lshlrev_b32 v240, 3, v1
s_mul_i32 s26, s26, 4224
v_mfma_f32_16x16x32_bf16 v[68:71], a[224:227], a[244:247], v[68:71]
s_lshl_b32 s73, s10, 7
s_add_u32 s26, s26, s73
v_mfma_f32_16x16x32_bf16 v[72:75], a[224:227], a[248:251], v[72:75]
buffer_load_dwordx4 v15, s[52:55], s71 offen offset:3072 lds
s_add_u32 s26, s26, 4194304
v_mfma_f32_16x16x32_bf16 v[76:79], a[224:227], a[252:255], v[76:79]
s_mul_i32 s79, s78, 221184
s_sub_u32 s71, s71, s79
s_waitcnt vmcnt(9)
s_barrier
s_lshl_b32 s86, s13, 7
s_add_u32 s86, s86, 160512
v_lshl_add_u32 v59, v3, 4, s86
s_add_u32 s13, s13, 1
s_cmp_eq_u32 s13, 10
s_cselect_b32 s13, 0, s13
s_nop 0
ds_read_b128 a[192:195], v59 offset:0
ds_read_b128 a[208:211], v16 offset:0
s_add_u32 m0, s72, 65536
ds_read_b128 a[212:215], v16 offset:2048
buffer_load_dwordx4 v8, s[48:51], s70 offen offset:0 lds
ds_read_b128 a[216:219], v16 offset:4096
ds_read_b128 a[220:223], v16 offset:6144
v_lshrrev_b32_e64 v6, 3, v1
v_and_b32 v7, 0x70, v5
v_mul_u32_u24 v236, 4224, v6
buffer_load_dwordx4 v9, s[48:51], s70 offen offset:1024 lds
v_add_u32 v236, v236, v7
v_add_u32 v6, s74, v6
v_mul_u32_u24 v6, 160, v6
v_add_u32 v6, 122880, v6
v_add_u32 v237, v6, v7
v_lshrrev_b32 v6, 2, v1
v_mul_u32_u24 v6, 160, v6
buffer_load_dwordx4 v10, s[48:51], s70 offen offset:2048 lds
v_and_b32_e64 v7, 0x18, v240
s_lshl_b32 s73, s93, 5
s_waitcnt lgkmcnt(0)
v_mfma_f32_16x16x32_bf16 v[64:67], a[192:195], a[208:211], v[64:67]
ds_read_b128 a[224:227], v59 offset:64
s_add_u32 s73, s73, 122880
v_mfma_f32_16x16x32_bf16 v[68:71], a[192:195], a[212:215], v[68:71]
ds_read_b128 a[240:243], v17 offset:0
v_add3_u32 v238, v6, v7, s73
v_mfma_f32_16x16x32_bf16 v[72:75], a[192:195], a[216:219], v[72:75]
ds_read_b128 a[244:247], v17 offset:2048
buffer_load_dwordx4 v11, s[48:51], s70 offen offset:3072 lds
v_mfma_f32_16x16x32_bf16 v[76:79], a[192:195], a[220:223], v[76:79]
ds_read_b128 a[248:251], v17 offset:4096
s_mul_i32 s73, s3, 2816
ds_read_b128 a[252:255], v17 offset:6144
v_mul_u32_u24 v6, 176, v2
s_add_u32 m0, s72, 81920
v_lshl_add_u32 v6, v3, 3, v6
buffer_load_dwordx4 v12, s[52:55], s71 offen offset:0 lds
v_add_u32 v241, s73, v6
v_add_u32 v239, 0, v1
v_mul_u32_u24 v6, 6554, v239
v_lshrrev_b32_e64 v6, 16, v6
v_add_lshl_u32 v7, v239, v6, 4
v_add_u32_e64 v242, s73, v7
buffer_load_dwordx4 v13, s[52:55], s71 offen offset:1024 lds
v_mul_u32_u24 v6, 1104, v6
v_add_u32 v245, v6, v7
v_add_u32_e64 v239, 64, v1
s_add_u32 s12, s12, 1
s_cmp_eq_u32 s12, 10
s_cselect_b32 s78, 9, -1
s_mul_i32 s79, s78, 128
s_sub_u32 s70, s70, s79
buffer_load_dwordx4 v14, s[52:55], s71 offen offset:2048 lds
v_mul_u32_u24 v6, 6554, v239
s_cmp_eq_u32 s12, 10
s_cselect_b32 s12, 0, s12
s_waitcnt lgkmcnt(0)
v_mfma_f32_16x16x32_bf16 v[64:67], a[224:227], a[240:243], v[64:67]
v_lshrrev_b32_e64 v6, 16, v6
v_add_lshl_u32 v7, v239, v6, 4
v_mfma_f32_16x16x32_bf16 v[68:71], a[224:227], a[244:247], v[68:71]
v_add_u32_e64 v243, s73, v7
v_mul_u32_u24 v6, 1104, v6
v_mfma_f32_16x16x32_bf16 v[72:75], a[224:227], a[248:251], v[72:75]
buffer_load_dwordx4 v15, s[52:55], s71 offen offset:3072 lds
v_add_u32_e64 v246, v6, v7
v_mfma_f32_16x16x32_bf16 v[76:79], a[224:227], a[252:255], v[76:79]
s_mul_i32 s79, s78, 221184
s_sub_u32 s71, s71, s79
s_waitcnt vmcnt(8)
s_barrier
s_lshl_b32 s86, s13, 7
s_add_u32 s86, s86, 160512
v_lshl_add_u32 v59, v3, 4, s86
s_add_u32 s13, s13, 1
s_cmp_eq_u32 s13, 10
s_cselect_b32 s13, 0, s13
ds_read_b128 a[192:195], v59 offset:0
ds_read_b128 a[208:211], v16 offset:32768
s_add_u32 m0, s72, 0
ds_read_b128 a[212:215], v16 offset:34816
buffer_load_dwordx4 v8, s[48:51], s70 offen offset:0 lds
ds_read_b128 a[216:219], v16 offset:36864
ds_read_b128 a[220:223], v16 offset:38912
v_add_u32 v239, 128, v1
v_mul_u32_u24 v6, 6554, v239
v_lshrrev_b32_e64 v6, 16, v6
buffer_load_dwordx4 v9, s[48:51], s70 offen offset:1024 lds
v_add_lshl_u32 v7, v239, v6, 4
v_add_u32_e64 v244, s73, v7
v_mul_u32_u24 v6, 1104, v6
v_add_u32 v247, v6, v7
s_lshl2_add_u32 s28, s10, s93
s_mul_i32 s27, s28, 20480
s_mul_i32 s73, s11, 160
buffer_load_dwordx4 v10, s[48:51], s70 offen offset:2048 lds
s_add_u32 s27, s27, s73
s_lshl_b32 s28, s28, 6
s_waitcnt lgkmcnt(0)
v_mfma_f32_16x16x32_bf16 v[64:67], a[192:195], a[208:211], v[64:67]
ds_read_b128 a[224:227], v59 offset:64
s_add_u32 s28, s28, 196608
v_mfma_f32_16x16x32_bf16 v[68:71], a[192:195], a[212:215], v[68:71]
ds_read_b128 a[240:243], v17 offset:32768
v_lshlrev_b32 v239, 2, v2
v_mfma_f32_16x16x32_bf16 v[72:75], a[192:195], a[216:219], v[72:75]
ds_read_b128 a[244:247], v17 offset:34816
buffer_load_dwordx4 v11, s[48:51], s70 offen offset:3072 lds
v_mfma_f32_16x16x32_bf16 v[76:79], a[192:195], a[220:223], v[76:79]
ds_read_b128 a[248:251], v17 offset:36864
v_lshlrev_b32_e64 v140, 4, v2
ds_read_b128 a[252:255], v17 offset:38912
v_lshrrev_b32_e64 v6, 1, v3
s_add_u32 m0, s72, 16384
v_lshl_add_u32 v6, v6, 8, v140
buffer_load_dwordx4 v12, s[52:55], s71 offen offset:0 lds
v_and_b32_e64 v7, 1, v3
v_lshl_add_u32 v6, v7, 3, v6
v_sub_u32_e64 v51, s87, v6
v_lshl_add_u32 v6, v3, 8, v140
v_sub_u32 v52, s87, v6
v_lshrrev_b32 v141, 1, v2
buffer_load_dwordx4 v13, s[52:55], s71 offen offset:1024 lds
v_and_b32_e64 v142, 1, v2
v_lshl_add_u32 v6, v3, 4, v141
v_lshlrev_b32 v6, 2, v6
s_add_u32 s12, s12, 1
s_cmp_eq_u32 s12, 10
s_cselect_b32 s78, 9, -1
s_mul_i32 s79, s78, 128
s_sub_u32 s70, s70, s79
buffer_load_dwordx4 v14, s[52:55], s71 offen offset:2048 lds
v_lshl_add_u32 v7, v142, 8, s87
s_cmp_eq_u32 s12, 10
s_cselect_b32 s12, 0, s12
s_waitcnt lgkmcnt(0)
v_mfma_f32_16x16x32_bf16 v[64:67], a[224:227], a[240:243], v[64:67]
v_sub_u32_e64 v53, v7, v6
v_lshl_add_u32 v6, v3, 5, v141
v_mfma_f32_16x16x32_bf16 v[68:71], a[224:227], a[244:247], v[68:71]
v_lshlrev_b32_e64 v6, 2, v6
v_lshl_add_u32 v7, v142, 1, s87
v_mfma_f32_16x16x32_bf16 v[72:75], a[224:227], a[248:251], v[72:75]
buffer_load_dwordx4 v15, s[52:55], s71 offen offset:3072 lds
v_sub_u32_e64 v54, v7, v6
v_mfma_f32_16x16x32_bf16 v[76:79], a[224:227], a[252:255], v[76:79]
s_mul_i32 s79, s78, 221184
s_sub_u32 s71, s71, s79
s_waitcnt vmcnt(8)
s_barrier
s_lshl_b32 s86, s13, 7
s_add_u32 s86, s86, 160512
v_lshl_add_u32 v59, v3, 4, s86
s_add_u32 s13, s13, 1
s_cmp_eq_u32 s13, 10
s_cselect_b32 s13, 0, s13
s_nop 0
ds_read_b128 a[192:195], v59 offset:0
ds_read_b128 a[208:211], v18 offset:0
s_add_u32 m0, s72, 32768
ds_read_b128 a[212:215], v18 offset:2048
buffer_load_dwordx4 v8, s[48:51], s70 offen offset:0 lds
ds_read_b128 a[216:219], v18 offset:4096
ds_read_b128 a[220:223], v18 offset:6144
v_mov_b32 v55, s87
v_lshlrev_b32 v143, 2, v3
v_sub_u32_e64 v6, v143, v141
buffer_load_dwordx4 v9, s[48:51], s70 offen offset:1024 lds
v_lshl_add_u32 v6, v6, 2, s87
v_mul_u32_u24 v225, 1216, v142
v_add_u32 v6, 8732, v6
v_add_u32_e64 v225, v225, v6
v_add_u32 v226, 512, v225
v_sub_u32_e64 v6, v143, v2
v_lshl_add_u32 v6, v6, 2, s87
buffer_load_dwordx4 v10, s[48:51], s70 offen offset:2048 lds
v_add_u32 v227, 11196, v6
v_lshl_add_u32 v6, v2, 5, s87
s_waitcnt lgkmcnt(0)
v_mfma_f32_16x16x32_bf16 v[64:67], a[192:195], a[208:211], v[64:67]
ds_read_b128 a[224:227], v59 offset:64
v_lshl_add_u32 v224, v3, 4, v6
v_mfma_f32_16x16x32_bf16 v[68:71], a[192:195], a[212:215], v[68:71]
ds_read_b128 a[240:243], v19 offset:0
v_lshl_add_u32 v228, v3, 3, v6
v_mfma_f32_16x16x32_bf16 v[72:75], a[192:195], a[216:219], v[72:75]
ds_read_b128 a[244:247], v19 offset:2048
buffer_load_dwordx4 v11, s[48:51], s70 offen offset:3072 lds
v_mfma_f32_16x16x32_bf16 v[76:79], a[192:195], a[220:223], v[76:79]
s_nop 0
ds_read_b128 a[248:251], v19 offset:4096
s_mov_b32 s88, 0x00010001
ds_read_b128 a[252:255], v19 offset:6144
s_mov_b32 s89, 0x3f80
s_add_u32 m0, s72, 49152
v_lshlrev_b32_e64 v140, 3, v3
buffer_load_dwordx4 v12, s[52:55], s71 offen offset:0 lds
v_add_u32_e64 v6, 11, v2
v_bfm_b32 v6, 3, v6
v_bfe_u32 v6, v6, v140, 8
v_lshl_or_b32 v6, v6, 15, v6
v_and_b32 v7, s88, v6
v_mul_u32_u24 v28, s89, v7
buffer_load_dwordx4 v13, s[52:55], s71 offen offset:1024 lds
v_lshrrev_b32 v7, 2, v6
v_and_b32 v7, s88, v7
v_mul_u32_u24 v29, s89, v7
s_add_u32 s12, s12, 1
s_cmp_eq_u32 s12, 10
s_cselect_b32 s78, 9, -1
s_mul_i32 s79, s78, 128
s_sub_u32 s70, s70, s79
buffer_load_dwordx4 v14, s[52:55], s71 offen offset:2048 lds
v_lshrrev_b32_e64 v7, 4, v6
s_cmp_eq_u32 s12, 10
s_cselect_b32 s12, 0, s12
s_waitcnt lgkmcnt(0)
v_mfma_f32_16x16x32_bf16 v[64:67], a[224:227], a[240:243], v[64:67]
v_and_b32 v7, s88, v7
v_mul_u32_u24 v30, s89, v7
v_mfma_f32_16x16x32_bf16 v[68:71], a[224:227], a[244:247], v[68:71]
v_lshrrev_b32 v7, 6, v6
v_and_b32 v7, s88, v7
v_mfma_f32_16x16x32_bf16 v[72:75], a[224:227], a[248:251], v[72:75]
buffer_load_dwordx4 v15, s[52:55], s71 offen offset:3072 lds
v_mul_u32_u24_e64 v31, s89, v7
v_mfma_f32_16x16x32_bf16 v[76:79], a[224:227], a[252:255], v[76:79]
s_mul_i32 s79, s78, 221184
s_sub_u32 s71, s71, s79
s_waitcnt vmcnt(8)
s_barrier
s_lshl_b32 s86, s13, 7
s_add_u32 s86, s86, 160512
v_lshl_add_u32 v59, v3, 4, s86
s_add_u32 s13, s13, 1
s_cmp_eq_u32 s13, 10
s_cselect_b32 s13, 0, s13
s_nop 0
ds_read_b128 a[192:195], v59 offset:0
ds_read_b128 a[208:211], v16 offset:0
s_add_u32 m0, s72, 65536
ds_read_b128 a[212:215], v16 offset:2048
buffer_load_dwordx4 v8, s[48:51], s70 offen offset:0 lds
ds_read_b128 a[216:219], v16 offset:4096
ds_read_b128 a[220:223], v16 offset:6144
v_add_u32_e64 v6, 6, v2
v_bfm_b32 v6, 5, v6
v_bfe_u32 v6, v6, v140, 8
buffer_load_dwordx4 v9, s[48:51], s70 offen offset:1024 lds
v_lshl_or_b32 v6, v6, 15, v6
v_and_b32 v7, s88, v6
v_mul_u32_u24 v32, s89, v7
v_lshrrev_b32 v7, 2, v6
v_and_b32 v7, s88, v7
v_mul_u32_u24 v33, s89, v7
v_lshrrev_b32 v7, 4, v6
buffer_load_dwordx4 v10, s[48:51], s70 offen offset:2048 lds
v_and_b32 v7, s88, v7
v_mul_u32_u24_e64 v34, s89, v7
s_waitcnt lgkmcnt(0)
v_mfma_f32_16x16x32_bf16 v[64:67], a[192:195], a[208:211], v[64:67]
ds_read_b128 a[224:227], v59 offset:64
v_lshrrev_b32_e64 v7, 6, v6
v_mfma_f32_16x16x32_bf16 v[68:71], a[192:195], a[212:215], v[68:71]
ds_read_b128 a[240:243], v17 offset:0
v_and_b32_e64 v7, s88, v7
v_mfma_f32_16x16x32_bf16 v[72:75], a[192:195], a[216:219], v[72:75]
ds_read_b128 a[244:247], v17 offset:2048
buffer_load_dwordx4 v11, s[48:51], s70 offen offset:3072 lds
v_mfma_f32_16x16x32_bf16 v[76:79], a[192:195], a[220:223], v[76:79]
ds_read_b128 a[248:251], v17 offset:4096
v_mul_u32_u24_e64 v35, s89, v7
ds_read_b128 a[252:255], v17 offset:6144
v_add_u32_e64 v6, 5, v2
s_add_u32 m0, s72, 81920
v_bfm_b32 v6, 7, v6
buffer_load_dwordx4 v12, s[52:55], s71 offen offset:0 lds
v_bfe_u32 v6, v6, v140, 8
v_lshl_or_b32 v6, v6, 15, v6
v_and_b32 v7, s88, v6
v_mul_u32_u24 v36, s89, v7
v_lshrrev_b32 v7, 2, v6
v_and_b32 v7, s88, v7
buffer_load_dwordx4 v13, s[52:55], s71 offen offset:1024 lds
v_mul_u32_u24 v37, s89, v7
v_lshrrev_b32 v7, 4, v6
v_and_b32 v7, s88, v7
s_add_u32 s12, s12, 1
s_cmp_eq_u32 s12, 10
s_cselect_b32 s78, 9, -1
s_mul_i32 s79, s78, 128
s_sub_u32 s70, s70, s79
buffer_load_dwordx4 v14, s[52:55], s71 offen offset:2048 lds
v_mul_u32_u24_e64 v38, s89, v7
s_cmp_eq_u32 s12, 10
s_cselect_b32 s12, 0, s12
s_waitcnt lgkmcnt(0)
v_mfma_f32_16x16x32_bf16 v[64:67], a[224:227], a[240:243], v[64:67]
v_lshrrev_b32 v7, 6, v6
v_and_b32 v7, s88, v7
v_mfma_f32_16x16x32_bf16 v[68:71], a[224:227], a[244:247], v[68:71]
v_mul_u32_u24 v39, s89, v7
v_add_u32 v6, 4, v2
v_mfma_f32_16x16x32_bf16 v[72:75], a[224:227], a[248:251], v[72:75]
buffer_load_dwordx4 v15, s[52:55], s71 offen offset:3072 lds
v_bfm_b32 v6, 9, v6
v_mfma_f32_16x16x32_bf16 v[76:79], a[224:227], a[252:255], v[76:79]
s_mul_i32 s79, s78, 221184
s_sub_u32 s71, s71, s79
s_waitcnt vmcnt(8)
s_barrier
s_lshl_b32 s86, s13, 7
s_add_u32 s86, s86, 160512
v_lshl_add_u32 v59, v3, 4, s86
s_add_u32 s13, s13, 1
s_cmp_eq_u32 s13, 10
s_cselect_b32 s13, 0, s13
ds_read_b128 a[192:195], v59 offset:0
ds_read_b128 a[208:211], v16 offset:32768
s_add_u32 m0, s72, 0
ds_read_b128 a[212:215], v16 offset:34816
buffer_load_dwordx4 v8, s[48:51], s70 offen offset:0 lds
ds_read_b128 a[216:219], v16 offset:36864
ds_read_b128 a[220:223], v16 offset:38912
buffer_load_dwordx2 v[56:57], v229, s[56:59], 0 offen sc1
v_bfe_u32 v6, v6, v140, 8
v_lshl_or_b32 v6, v6, 15, v6
buffer_load_dwordx4 v9, s[48:51], s70 offen offset:1024 lds
v_and_b32 v7, s88, v6
v_mul_u32_u24 v40, s89, v7
v_lshrrev_b32 v7, 2, v6
v_and_b32 v7, s88, v7
v_mul_u32_u24 v41, s89, v7
v_lshrrev_b32 v7, 4, v6
v_and_b32_e64 v7, s88, v7
buffer_load_dwordx4 v10, s[48:51], s70 offen offset:2048 lds
v_mul_u32_u24 v42, s89, v7
v_lshrrev_b32_e64 v7, 6, v6
s_waitcnt lgkmcnt(0)
v_mfma_f32_16x16x32_bf16 v[64:67], a[192:195], a[208:211], v[64:67]
ds_read_b128 a[224:227], v59 offset:64
v_and_b32_e64 v7, s88, v7
v_mfma_f32_16x16x32_bf16 v[68:71], a[192:195], a[212:215], v[68:71]
ds_read_b128 a[240:243], v17 offset:32768
v_mul_u32_u24_e64 v43, s89, v7
v_mfma_f32_16x16x32_bf16 v[72:75], a[192:195], a[216:219], v[72:75]
ds_read_b128 a[244:247], v17 offset:34816
buffer_load_dwordx4 v11, s[48:51], s70 offen offset:3072 lds
v_mfma_f32_16x16x32_bf16 v[76:79], a[192:195], a[220:223], v[76:79]
ds_read_b128 a[248:251], v17 offset:36864
s_mov_b32 s89, 0xffff
ds_read_b128 a[252:255], v17 offset:38912
v_add_u32_e64 v6, 12, v2
s_add_u32 m0, s72, 16384
v_bfm_b32 v6, 2, v6
buffer_load_dwordx4 v12, s[52:55], s71 offen offset:0 lds
v_bfe_u32 v6, v6, v140, 8
v_lshl_or_b32 v6, v6, 15, v6
v_and_b32 v7, s88, v6
v_mul_u32_u24 v44, s89, v7
v_lshrrev_b32 v7, 2, v6
v_and_b32 v7, s88, v7
buffer_load_dwordx4 v13, s[52:55], s71 offen offset:1024 lds
v_mul_u32_u24 v45, s89, v7
v_lshrrev_b32 v7, 4, v6
v_and_b32 v7, s88, v7
v_mul_u32_u24 v46, s89, v7
v_lshrrev_b32 v7, 6, v6
v_and_b32 v7, s88, v7
v_mul_u32_u24_e64 v47, s89, v7
buffer_load_dwordx4 v14, s[52:55], s71 offen offset:2048 lds
s_mul_i32 s74, s80, 4352
s_add_u32 s74, s74, 1048576
s_waitcnt vmcnt(6)
v_cmp_ne_u64 vcc, s[68:69], v[56:57]
s_cbranch_vccnz Lsp_27
Lsd_28:
s_waitcnt lgkmcnt(0)
v_mfma_f32_16x16x32_bf16 v[64:67], a[224:227], a[240:243], v[64:67]
v_mfma_f32_16x16x32_bf16 v[68:71], a[224:227], a[244:247], v[68:71]
v_mfma_f32_16x16x32_bf16 v[72:75], a[224:227], a[248:251], v[72:75]
buffer_load_dwordx4 v15, s[52:55], s71 offen offset:3072 lds
v_mfma_f32_16x16x32_bf16 v[76:79], a[224:227], a[252:255], v[76:79]
buffer_load_dwordx4 v[144:147], v5, s[56:59], s74 offen offset:0 sc1
s_barrier
s_lshl_b32 s86, s13, 7
s_add_u32 s86, s86, 160512
v_lshl_add_u32 v59, v3, 4, s86
s_add_u32 s13, s13, 1
s_cmp_eq_u32 s13, 10
s_cselect_b32 s13, 0, s13
s_nop 0
ds_read_b128 a[192:195], v59 offset:0
ds_read_b128 a[208:211], v18 offset:0
ds_read_b128 a[212:215], v18 offset:2048
ds_read_b128 a[216:219], v18 offset:4096
buffer_load_dwordx4 v[148:151], v5, s[56:59], s74 offen offset:1024 sc1
ds_read_b128 a[220:223], v18 offset:6144
buffer_load_dwordx4 v[152:155], v5, s[56:59], s74 offen offset:2048 sc1
buffer_load_dwordx4 v[156:159], v5, s[56:59], s74 offen offset:3072 sc1
s_waitcnt lgkmcnt(0)
v_mfma_f32_16x16x32_bf16 v[64:67], a[192:195], a[208:211], v[64:67]
ds_read_b128 a[224:227], v59 offset:64
v_mfma_f32_16x16x32_bf16 v[68:71], a[192:195], a[212:215], v[68:71]
ds_read_b128 a[240:243], v19 offset:0
v_mfma_f32_16x16x32_bf16 v[72:75], a[192:195], a[216:219], v[72:75]
ds_read_b128 a[244:247], v19 offset:2048
v_mfma_f32_16x16x32_bf16 v[76:79], a[192:195], a[220:223], v[76:79]
s_nop 0
ds_read_b128 a[248:251], v19 offset:4096
s_add_u32 s77, s84, 4096
buffer_load_dwordx4 a[128:131], v5, s[56:59], s77 offen offset:1024 sc1
ds_read_b128 a[252:255], v19 offset:6144
buffer_load_dwordx4 a[132:135], v5, s[56:59], s77 offen offset:2048 sc1
v_mov_b32 v248, 163328
ds_write_b32 v248, v58
s_add_u32 s77, s84, 57344
buffer_load_dwordx4 a[136:139], v5, s[56:59], s77 offen offset:0 sc1
s_and_b32 s73, s3, 1
s_lshl1_add_u32 s73, s8, s73
s_lshl_b32 s100, s73, 5
s_add_u32 s100, s100, s14
s_lshl_b32 s100, s100, 6
s_add_u32 s100, s100, 32768
s_mul_i32 s90, s73, 229376
s_lshl_b32 s91, s14, 11
s_add_u32 s90, s90, s91
buffer_load_dwordx4 a[140:143], v5, s[56:59], s77 offen offset:1024 sc1
s_waitcnt lgkmcnt(1)
v_mfma_f32_16x16x32_bf16 v[64:67], a[224:227], a[240:243], v[64:67]
s_add_u32 s90, s90, 10485760
s_lshl_b32 s91, s73, 8
v_mfma_f32_16x16x32_bf16 v[68:71], a[224:227], a[244:247], v[68:71]
v_mfma_f32_16x16x32_bf16 v[72:75], a[224:227], a[248:251], v[72:75]
v_mfma_f32_16x16x32_bf16 v[76:79], a[224:227], a[252:255], v[76:79]
buffer_load_dwordx4 a[144:147], v5, s[56:59], s77 offen offset:2048 sc1
s_waitcnt lgkmcnt(0)
s_waitcnt vmcnt(9)
s_barrier
s_lshl_b32 s86, s13, 7
s_add_u32 s86, s86, 160512
v_lshl_add_u32 v59, v3, 4, s86
s_add_u32 s13, s13, 1
s_cmp_eq_u32 s13, 10
s_cselect_b32 s13, 0, s13
ds_read_b128 a[192:195], v59 offset:0
ds_read_b128 a[208:211], v16 offset:0
ds_read_b128 a[212:215], v16 offset:2048
ds_read_b128 a[216:219], v16 offset:4096
buffer_load_dwordx4 a[148:151], v5, s[56:59], s77 offen offset:3072 sc1
ds_read_b128 a[220:223], v16 offset:6144
s_add_u32 s77, s84, 61440
buffer_load_dwordx4 a[152:155], v5, s[56:59], s77 offen offset:0 sc1
buffer_load_dwordx4 a[156:159], v5, s[56:59], s77 offen offset:1024 sc1
s_waitcnt lgkmcnt(0)
v_mfma_f32_16x16x32_bf16 v[64:67], a[192:195], a[208:211], v[64:67]
ds_read_b128 a[224:227], v59 offset:64
v_mfma_f32_16x16x32_bf16 v[68:71], a[192:195], a[212:215], v[68:71]
ds_read_b128 a[240:243], v17 offset:0
v_mfma_f32_16x16x32_bf16 v[72:75], a[192:195], a[216:219], v[72:75]
ds_read_b128 a[244:247], v17 offset:2048
v_mfma_f32_16x16x32_bf16 v[76:79], a[192:195], a[220:223], v[76:79]
s_nop 0
ds_read_b128 a[248:251], v17 offset:4096
buffer_load_dwordx4 a[160:163], v5, s[56:59], s77 offen offset:2048 sc1
ds_read_b128 a[252:255], v17 offset:6144
s_add_u32 s77, s84, 114688
buffer_load_dwordx4 a[164:167], v5, s[56:59], s77 offen offset:0 sc1
buffer_load_dwordx4 a[168:171], v5, s[56:59], s77 offen offset:1024 sc1
buffer_load_dwordx4 a[172:175], v5, s[56:59], s77 offen offset:2048 sc1
buffer_load_dwordx4 a[176:179], v5, s[56:59], s77 offen offset:3072 sc1
s_waitcnt lgkmcnt(0)
s_barrier
s_waitcnt vmcnt(13)
ds_write_b128 v48, v[144:147] offset:512
ds_write_b128 v48, v[148:151] offset:1536
s_add_u32 s77, s84, 118784
buffer_load_dwordx4 a[180:183], v5, s[56:59], s77 offen offset:0 sc1
v_mfma_f32_16x16x32_bf16 v[64:67], a[224:227], a[240:243], v[64:67]
v_mfma_f32_16x16x32_bf16 v[68:71], a[224:227], a[244:247], v[68:71]
v_mfma_f32_16x16x32_bf16 v[72:75], a[224:227], a[248:251], v[72:75]
ds_write_b128 v48, v[152:155] offset:2560
v_mfma_f32_16x16x32_bf16 v[76:79], a[224:227], a[252:255], v[76:79]
ds_write_b128 v48, v[156:159] offset:3584
v_mfma_f32_16x16x32_bf16 v[160:163], a[32:35], a[0:3], 0
v_mfma_f32_16x16x32_bf16 v[164:167], a[64:67], a[0:3], 0
v_mfma_f32_16x16x32_bf16 v[168:171], a[96:99], a[0:3], 0
v_mfma_f32_16x16x32_bf16 v[160:163], a[36:39], a[4:7], v[160:163]
v_mfma_f32_16x16x32_bf16 v[164:167], a[68:71], a[4:7], v[164:167]
v_mfma_f32_16x16x32_bf16 v[168:171], a[100:103], a[4:7], v[168:171]
v_mfma_f32_16x16x32_bf16 v[160:163], a[40:43], a[8:11], v[160:163]
v_mfma_f32_16x16x32_bf16 v[164:167], a[72:75], a[8:11], v[164:167]
v_mfma_f32_16x16x32_bf16 v[168:171], a[104:107], a[8:11], v[168:171]
v_mfma_f32_16x16x32_bf16 v[160:163], a[44:47], a[12:15], v[160:163]
v_mfma_f32_16x16x32_bf16 v[164:167], a[76:79], a[12:15], v[164:167]
v_mfma_f32_16x16x32_bf16 v[168:171], a[108:111], a[12:15], v[168:171]
v_mfma_f32_16x16x32_bf16 v[160:163], a[48:51], a[16:19], v[160:163]
v_mfma_f32_16x16x32_bf16 v[164:167], a[80:83], a[16:19], v[164:167]
v_mfma_f32_16x16x32_bf16 v[168:171], a[112:115], a[16:19], v[168:171]
v_mfma_f32_16x16x32_bf16 v[160:163], a[52:55], a[20:23], v[160:163]
v_mfma_f32_16x16x32_bf16 v[164:167], a[84:87], a[20:23], v[164:167]
v_mfma_f32_16x16x32_bf16 v[168:171], a[116:119], a[20:23], v[168:171]
v_mfma_f32_16x16x32_bf16 v[160:163], a[56:59], a[24:27], v[160:163]
v_mfma_f32_16x16x32_bf16 v[164:167], a[88:91], a[24:27], v[164:167]
v_mfma_f32_16x16x32_bf16 v[168:171], a[120:123], a[24:27], v[168:171]
v_mfma_f32_16x16x32_bf16 v[160:163], a[60:63], a[28:31], v[160:163]
v_mfma_f32_16x16x32_bf16 v[164:167], a[92:95], a[28:31], v[164:167]
v_mfma_f32_16x16x32_bf16 v[168:171], a[124:127], a[28:31], v[168:171]
v_cmp_eq_u32 vcc, 1, v3
s_nop 1
v_cndmask_b32 v64, v64, v68, vcc
v_cmp_eq_u32 vcc, 2, v3
s_nop 1
v_cndmask_b32 v64, v64, v72, vcc
v_cmp_eq_u32 vcc, 3, v3
s_nop 1
v_cndmask_b32 v64, v64, v76, vcc
v_mul_f32 v64, 0xbfb8aa3b, v64
v_exp_f32 v64, v64
s_nop 0
v_add_f32 v64, 1.0, v64
v_rcp_f32 v64, v64
v_lshlrev_b32_e64 v6, 2, v1
s_add_u32 s91, s91, 196608
buffer_store_dword v64, v6, s[56:59], s91 offen sc1
v_mov_b32 v68, 0
v_mov_b32 v69, 0
v_mov_b32 v70, 0
v_mov_b32_e64 v71, 0
s_add_u32 s75, s90, 0
buffer_store_dwordx4 v[68:71], v5, s[56:59], s75 offen offset:1024 sc1
s_add_u32 s75, s90, 57344
buffer_store_dwordx4 v[68:71], v5, s[56:59], s75 offen offset:1024 sc1
s_add_u32 s75, s90, 114688
buffer_store_dwordx4 v[68:71], v5, s[56:59], s75 offen offset:1024 sc1
s_add_u32 s75, s90, 172032
buffer_store_dwordx4 v[68:71], v5, s[56:59], s75 offen offset:1024 sc1
s_add_u32 s75, s90, 0
s_nop 0
buffer_store_dwordx4 v[68:71], v5, s[56:59], s75 offen offset:0 sc1
s_add_u32 s75, s90, 57344
buffer_store_dwordx4 v[68:71], v5, s[56:59], s75 offen offset:0 sc1
s_add_u32 s75, s90, 114688
buffer_store_dwordx4 v[68:71], v5, s[56:59], s75 offen offset:0 sc1
s_add_u32 s75, s90, 172032
buffer_store_dwordx4 v[68:71], v5, s[56:59], s75 offen offset:0 sc1
s_branch Lpost
Lfree:
s_lshl2_add_u32 s73, s4, s5
s_lshl_b32 s85, s3, 5
s_add_u32 s85, s85, s73
s_lshl_b32 s72, s3, 14
s_waitcnt lgkmcnt(0)
s_load_dwordx2 s[68:69], s[46:47], 0
s_mov_b64 s[48:49], s[16:17]
s_mov_b64 s[52:53], s[36:37]
s_mov_b64 s[56:57], s[46:47]
s_mov_b64 s[60:61], s[42:43]
s_mov_b64 s[64:65], s[46:47]
s_mov_b64 s[96:97], s[38:39]
v_lshlrev_b32 v6, 1, v3
v_xor_b32 v6, v6, v2
v_mul_u32_u24 v7, 1280, v3
v_lshl_add_u32 v48, v6, 4, v7
v_xor_b32_e64 v6, 8, v6
v_lshl_add_u32 v49, v6, 4, v7
s_mul_i32 s73, s85, 13108
s_lshr_b32 s73, s73, 16
s_mul_i32 s74, s73, 5
s_sub_u32 s74, s85, s74
s_mul_i32 s91, s73, 81920
s_lshl_b32 s75, s74, 8
s_add_u32 s91, s91, s75
s_add_u32 m0, s72, 0
s_add_u32 s78, s91, 0
s_nop 0
buffer_load_dwordx4 v48, s[96:99], s78 offen nt lds
s_add_u32 m0, s72, 1024
s_add_u32 s78, s91, 20480
buffer_load_dwordx4 v48, s[96:99], s78 offen nt lds
s_add_u32 m0, s72, 2048
s_add_u32 s78, s91, 5120
buffer_load_dwordx4 v49, s[96:99], s78 offen nt lds
s_add_u32 m0, s72, 3072
s_add_u32 s78, s91, 25600
buffer_load_dwordx4 v49, s[96:99], s78 offen nt lds
s_add_u32 m0, s72, 4096
s_add_u32 s78, s91, 10240
buffer_load_dwordx4 v48, s[96:99], s78 offen nt lds
s_add_u32 m0, s72, 5120
s_add_u32 s78, s91, 30720
buffer_load_dwordx4 v48, s[96:99], s78 offen nt lds
s_add_u32 m0, s72, 6144
s_add_u32 s78, s91, 15360
buffer_load_dwordx4 v49, s[96:99], s78 offen nt lds
s_add_u32 m0, s72, 7168
s_add_u32 s78, s91, 35840
buffer_load_dwordx4 v49, s[96:99], s78 offen nt lds
s_add_u32 m0, s72, 8192
s_add_u32 s78, s91, 40960
buffer_load_dwordx4 v48, s[96:99], s78 offen nt lds
s_add_u32 m0, s72, 9216
s_add_u32 s78, s91, 61440
buffer_load_dwordx4 v48, s[96:99], s78 offen nt lds
s_add_u32 m0, s72, 10240
s_add_u32 s78, s91, 46080
buffer_load_dwordx4 v49, s[96:99], s78 offen nt lds
s_add_u32 m0, s72, 11264
s_add_u32 s78, s91, 66560
buffer_load_dwordx4 v49, s[96:99], s78 offen nt lds
s_add_u32 m0, s72, 12288
s_add_u32 s78, s91, 51200
buffer_load_dwordx4 v48, s[96:99], s78 offen nt lds
s_add_u32 m0, s72, 13312
s_add_u32 s78, s91, 71680
buffer_load_dwordx4 v48, s[96:99], s78 offen nt lds
s_add_u32 m0, s72, 14336
s_add_u32 s78, s91, 56320
buffer_load_dwordx4 v49, s[96:99], s78 offen nt lds
s_add_u32 m0, s72, 15360
s_add_u32 s78, s91, 76800
buffer_load_dwordx4 v49, s[96:99], s78 offen nt lds
s_mul_i32 s90, s74, 458752
s_lshl_b32 s75, s73, 11
s_add_u32 s90, s90, s75
s_add_u32 s90, s90, 7340032
s_lshl_b32 s83, s85, 6
s_add_u32 s83, s83, 16384
v_lshrrev_b32 v6, 2, v2
v_and_b32_e64 v7, 1, v3
v_lshl_or_b32 v7, v7, 2, v6
v_lshl_add_u32 v6, v3, 3, v6
v_lshlrev_b32_e64 v6, 8, v6
v_lshl_add_u32 v6, v7, 5, v6
v_and_b32_e64 v7, 3, v2
v_lshl_add_u32 v50, v7, 3, v6
v_add_u32 v50, s72, v50
s_lshr_b32 s73, s101, 1
v_bfe_u32 v6, v1, 1, 2
v_add_u32 v6, s73, v6
v_mul_u32_u24 v6, 5, v6
s_mul_i32 s74, s11, 5
v_and_b32 v7, 1, v1
v_lshl_add_u32 v7, v7, 2, s74
v_lshrrev_b32_e64 v7, 3, v7
v_add_lshl_u32 v6, v6, v7, 6
v_add_u32 v229, 16384, v6
v_and_b32_e64 v6, 1, v1
v_lshl_add_u32 v6, v6, 2, s74
v_add_u32 v6, 20, v6
v_lshrrev_b32 v6, 3, v6
v_sub_u32_e64 v6, v6, v7
v_lshl_add_u32 v6, v6, 6, v229
v_cmp_lt_u32 vcc, 31, v1
s_nop 1
v_cndmask_b32 v229, v229, v6, vcc
v_and_b32 v6, 3, v1
v_add_u32 v6, s73, v6
v_and_b32 v7, 4, v1
v_lshl_add_u32 v6, v7, 3, v6
v_cmp_gt_u32 vcc, 8, v1
s_lshl_b32 s73, s10, 5
s_nop 0
v_cndmask_b32 v6, 27, v6, vcc
v_xor_b32 v6, s73, v6
v_lshlrev_b32 v6, 6, v6
v_add_u32 v230, 32768, v6
s_lshl_b32 s74, s101, 10
s_add_u32 s74, s74, 10485760
s_add_u32 s73, s93, 1
s_and_b32 s73, s73, 3
s_lshl2_add_u32 s22, s10, s73
s_xor_b32 s18, s22, 4
s_mul_i32 s18, s18, 57344
s_add_u32 s18, s18, s74
s_mul_i32 s22, s22, 57344
s_add_u32 s22, s22, s74
s_mul_i32 s73, s73, 15360
v_add_u32 v231, s73, v5
s_add_u32 s73, s93, 2
s_and_b32 s73, s73, 3
s_lshl2_add_u32 s23, s10, s73
s_xor_b32 s19, s23, 4
s_mul_i32 s19, s19, 57344
s_add_u32 s19, s19, s74
s_mul_i32 s23, s23, 57344
s_add_u32 s23, s23, s74
s_mul_i32 s73, s73, 15360
v_add_u32_e64 v232, s73, v5
s_add_u32 s73, s93, 3
s_and_b32 s73, s73, 3
s_lshl2_add_u32 s24, s10, s73
s_xor_b32 s20, s24, 4
s_mul_i32 s20, s20, 57344
s_add_u32 s20, s20, s74
s_mul_i32 s24, s24, 57344
s_add_u32 s24, s24, s74
s_mul_i32 s73, s73, 15360
v_add_u32_e64 v233, s73, v5
s_add_u32 s73, s93, 4
s_and_b32 s73, s73, 3
s_lshl2_add_u32 s25, s10, s73
s_xor_b32 s21, s25, 4
s_mul_i32 s21, s21, 57344
s_add_u32 s21, s21, s74
s_mul_i32 s25, s25, 57344
s_add_u32 s25, s25, s74
s_mul_i32 s73, s73, 15360
v_add_u32_e64 v234, s73, v5
s_mul_i32 s26, s11, 80
s_mul_i32 s74, s3, 20
s_add_u32 s26, s26, s74
v_add_lshl_u32 v6, v1, s26, 6
v_add_u32 v6, 131072, v6
s_lshl2_add_u32 s29, s2, s3
s_xor_b32 s34, s29, 4
s_lshl_b32 s35, s34, 6
s_add_u32 s35, s35, 262144
v_mov_b32 v7, s35
v_cmp_lt_u32_e64 vcc, 19, v1
s_xor_b32 s35, s35, 256
s_mul_i32 s29, s29, 2560
v_cndmask_b32_e64 v235, v6, v7, vcc
s_add_u32 s29, s29, 17825792
s_mul_i32 s34, s34, 2560
s_add_u32 s34, s34, 17825792
v_lshlrev_b32_e64 v240, 3, v1
s_mul_i32 s26, s26, 4224
s_lshl_b32 s73, s10, 7
s_add_u32 s26, s26, s73
s_add_u32 s26, s26, 4194304
v_lshrrev_b32_e64 v6, 3, v1
v_and_b32 v7, 0x70, v5
v_mul_u32_u24 v236, 4224, v6
v_add_u32 v236, v236, v7
v_add_u32 v6, s74, v6
v_mul_u32_u24 v6, 160, v6
v_add_u32 v6, 122880, v6
v_add_u32 v237, v6, v7
v_lshrrev_b32 v6, 2, v1
v_mul_u32_u24 v6, 160, v6
v_and_b32 v7, 0x18, v240
s_lshl_b32 s73, s93, 5
s_add_u32 s73, s73, 122880
v_add3_u32 v238, v6, v7, s73
s_mul_i32 s73, s3, 2816
v_mul_u32_u24 v6, 176, v2
v_lshl_add_u32 v6, v3, 3, v6
v_add_u32 v241, s73, v6
v_add_u32 v239, 0, v1
v_mul_u32_u24 v6, 6554, v239
v_lshrrev_b32_e64 v6, 16, v6
v_add_lshl_u32 v7, v239, v6, 4
v_add_u32_e64 v242, s73, v7
v_mul_u32_u24 v6, 1104, v6
v_add_u32 v245, v6, v7
v_add_u32 v239, 64, v1
v_mul_u32_u24 v6, 6554, v239
v_lshrrev_b32_e64 v6, 16, v6
v_add_lshl_u32 v7, v239, v6, 4
v_add_u32_e64 v243, s73, v7
v_mul_u32_u24 v6, 1104, v6
v_add_u32_e64 v246, v6, v7
v_add_u32 v239, 128, v1
v_mul_u32_u24 v6, 6554, v239
v_lshrrev_b32_e64 v6, 16, v6
v_add_lshl_u32 v7, v239, v6, 4
v_add_u32_e64 v244, s73, v7
v_mul_u32_u24 v6, 1104, v6
v_add_u32 v247, v6, v7
s_lshl2_add_u32 s28, s10, s93
s_mul_i32 s27, s28, 20480
s_mul_i32 s73, s11, 160
s_add_u32 s27, s27, s73
s_lshl_b32 s28, s28, 6
s_add_u32 s28, s28, 196608
v_lshlrev_b32 v239, 2, v2
s_waitcnt lgkmcnt(0)
s_mul_i32 s68, s68, 0x9e3779b1
s_add_u32 s68, s68, 0x7f4a7c15
s_mul_i32 s69, s69, 0x85ebca6b
s_add_u32 s69, s69, s68
s_or_b32 s69, s69, 1
v_mov_b32 v60, s68
v_mov_b32 v61, s69
s_waitcnt vmcnt(8)
v_xor_b32 v6, 0, v50
ds_read_b64_tr_b16 v[64:65], v6 offset:0
ds_read_b64_tr_b16 v[66:67], v6 offset:1024
v_xor_b32_e64 v6, 32, v50
ds_read_b64_tr_b16 v[72:73], v6 offset:0
ds_read_b64_tr_b16 v[74:75], v6 offset:1024
v_xor_b32_e64 v6, 64, v50
ds_read_b64_tr_b16 v[80:81], v6 offset:0
ds_read_b64_tr_b16 v[82:83], v6 offset:1024
v_xor_b32 v6, 96, v50
ds_read_b64_tr_b16 v[88:89], v6 offset:0
ds_read_b64_tr_b16 v[90:91], v6 offset:1024
v_xor_b32 v6, 128, v50
ds_read_b64_tr_b16 v[96:97], v6 offset:0
ds_read_b64_tr_b16 v[98:99], v6 offset:1024
v_xor_b32 v6, 160, v50
ds_read_b64_tr_b16 v[104:105], v6 offset:0
ds_read_b64_tr_b16 v[106:107], v6 offset:1024
v_xor_b32 v6, 192, v50
ds_read_b64_tr_b16 v[112:113], v6 offset:0
ds_read_b64_tr_b16 v[114:115], v6 offset:1024
v_xor_b32 v6, 224, v50
ds_read_b64_tr_b16 v[120:121], v6 offset:0
ds_read_b64_tr_b16 v[122:123], v6 offset:1024
s_add_u32 s76, s90, 0
s_waitcnt lgkmcnt(14)
buffer_store_dwordx4 v[64:67], v5, s[56:59], s76 offen offset:0 sc1
s_add_u32 s76, s90, 57344
s_waitcnt lgkmcnt(12)
buffer_store_dwordx4 v[72:75], v5, s[56:59], s76 offen offset:0 sc1
s_add_u32 s76, s90, 114688
s_waitcnt lgkmcnt(10)
buffer_store_dwordx4 v[80:83], v5, s[56:59], s76 offen offset:0 sc1
s_add_u32 s76, s90, 172032
s_waitcnt lgkmcnt(8)
buffer_store_dwordx4 v[88:91], v5, s[56:59], s76 offen offset:0 sc1
s_add_u32 s76, s90, 229376
s_waitcnt lgkmcnt(6)
buffer_store_dwordx4 v[96:99], v5, s[56:59], s76 offen offset:0 sc1
s_add_u32 s76, s90, 286720
s_waitcnt lgkmcnt(4)
buffer_store_dwordx4 v[104:107], v5, s[56:59], s76 offen offset:0 sc1
s_add_u32 s76, s90, 344064
s_waitcnt lgkmcnt(2)
buffer_store_dwordx4 v[112:115], v5, s[56:59], s76 offen offset:0 sc1
s_add_u32 s76, s90, 401408
s_waitcnt lgkmcnt(0)
buffer_store_dwordx4 v[120:123], v5, s[56:59], s76 offen offset:0 sc1
s_waitcnt vmcnt(8)
v_xor_b32_e64 v6, 0, v50
ds_read_b64_tr_b16 v[68:69], v6 offset:8192
ds_read_b64_tr_b16 v[70:71], v6 offset:9216
v_xor_b32_e64 v6, 32, v50
ds_read_b64_tr_b16 v[76:77], v6 offset:8192
ds_read_b64_tr_b16 v[78:79], v6 offset:9216
v_xor_b32_e64 v6, 64, v50
ds_read_b64_tr_b16 v[84:85], v6 offset:8192
ds_read_b64_tr_b16 v[86:87], v6 offset:9216
v_xor_b32 v6, 96, v50
ds_read_b64_tr_b16 v[92:93], v6 offset:8192
ds_read_b64_tr_b16 v[94:95], v6 offset:9216
v_xor_b32 v6, 128, v50
ds_read_b64_tr_b16 v[100:101], v6 offset:8192
ds_read_b64_tr_b16 v[102:103], v6 offset:9216
v_xor_b32 v6, 160, v50
ds_read_b64_tr_b16 v[108:109], v6 offset:8192
ds_read_b64_tr_b16 v[110:111], v6 offset:9216
v_xor_b32 v6, 192, v50
ds_read_b64_tr_b16 v[116:117], v6 offset:8192
ds_read_b64_tr_b16 v[118:119], v6 offset:9216
v_xor_b32 v6, 224, v50
ds_read_b64_tr_b16 v[124:125], v6 offset:8192
ds_read_b64_tr_b16 v[126:127], v6 offset:9216
s_add_u32 s76, s90, 0
s_waitcnt lgkmcnt(14)
buffer_store_dwordx4 v[68:71], v5, s[56:59], s76 offen offset:1024 sc1
s_add_u32 s76, s90, 57344
s_waitcnt lgkmcnt(12)
buffer_store_dwordx4 v[76:79], v5, s[56:59], s76 offen offset:1024 sc1
s_add_u32 s76, s90, 114688
s_waitcnt lgkmcnt(10)
buffer_store_dwordx4 v[84:87], v5, s[56:59], s76 offen offset:1024 sc1
s_add_u32 s76, s90, 172032
s_waitcnt lgkmcnt(8)
buffer_store_dwordx4 v[92:95], v5, s[56:59], s76 offen offset:1024 sc1
s_add_u32 s76, s90, 229376
s_waitcnt lgkmcnt(6)
buffer_store_dwordx4 v[100:103], v5, s[56:59], s76 offen offset:1024 sc1
s_add_u32 s76, s90, 286720
s_waitcnt lgkmcnt(4)
buffer_store_dwordx4 v[108:111], v5, s[56:59], s76 offen offset:1024 sc1
s_add_u32 s76, s90, 344064
s_waitcnt lgkmcnt(2)
buffer_store_dwordx4 v[116:119], v5, s[56:59], s76 offen offset:1024 sc1
s_add_u32 s76, s90, 401408
s_waitcnt lgkmcnt(0)
buffer_store_dwordx4 v[124:127], v5, s[56:59], s76 offen offset:1024 sc1
s_waitcnt vmcnt(0)
s_mov_b64 exec, 1
buffer_store_dwordx2 v[60:61], off, s[56:59], s83 sc1
s_mov_b64 exec, -1
s_barrier
buffer_load_dwordx2 v[56:57], v229, s[56:59], 0 offen sc1
s_waitcnt vmcnt(0)
v_cmp_ne_u64 vcc, s[68:69], v[56:57]
s_cbranch_vccnz Lsp_29
Lsd_30:
v_min_u32 v6, 55, v1
v_lshlrev_b32_e64 v6, 7, v6
s_add_u32 s77, s84, 0
buffer_load_dwordx4 a[108:111], v5, s[56:59], s77 offen offset:0 sc1
buffer_load_dwordx4 a[112:115], v5, s[56:59], s77 offen offset:1024 sc1
buffer_load_dwordx4 a[116:119], v5, s[56:59], s77 offen offset:2048 sc1
buffer_load_dwordx4 a[120:123], v5, s[56:59], s77 offen offset:3072 sc1
s_add_u32 s77, s84, 4096
buffer_load_dwordx4 a[124:127], v5, s[56:59], s77 offen offset:0 sc1
buffer_load_dwordx4 a[128:131], v5, s[56:59], s77 offen offset:1024 sc1
buffer_load_dwordx4 a[132:135], v5, s[56:59], s77 offen offset:2048 sc1
s_add_u32 s77, s84, 57344
buffer_load_dwordx4 a[136:139], v5, s[56:59], s77 offen offset:0 sc1
buffer_load_dwordx4 a[140:143], v5, s[56:59], s77 offen offset:1024 sc1
buffer_load_dwordx4 a[144:147], v5, s[56:59], s77 offen offset:2048 sc1
buffer_load_dwordx4 a[148:151], v5, s[56:59], s77 offen offset:3072 sc1
s_add_u32 s77, s84, 61440
buffer_load_dwordx4 a[152:155], v5, s[56:59], s77 offen offset:0 sc1
buffer_load_dwordx4 a[156:159], v5, s[56:59], s77 offen offset:1024 sc1
buffer_load_dwordx4 a[160:163], v5, s[56:59], s77 offen offset:2048 sc1
s_add_u32 s77, s84, 114688
buffer_load_dwordx4 a[164:167], v5, s[56:59], s77 offen offset:0 sc1
buffer_load_dwordx4 a[168:171], v5, s[56:59], s77 offen offset:1024 sc1
buffer_load_dwordx4 a[172:175], v5, s[56:59], s77 offen offset:2048 sc1
buffer_load_dwordx4 a[176:179], v5, s[56:59], s77 offen offset:3072 sc1
s_add_u32 s77, s84, 118784
buffer_load_dwordx4 a[180:183], v5, s[56:59], s77 offen offset:0 sc1
buffer_load_dwordx4 a[184:187], v5, s[56:59], s77 offen offset:1024 sc1
buffer_load_dwordx4 a[188:191], v5, s[56:59], s77 offen offset:2048 sc1
s_add_u32 s77, s84, 172032
buffer_load_dwordx4 a[192:195], v5, s[56:59], s77 offen offset:0 sc1
buffer_load_dwordx4 a[196:199], v5, s[56:59], s77 offen offset:1024 sc1
buffer_load_dwordx4 a[200:203], v5, s[56:59], s77 offen offset:2048 sc1
buffer_load_dwordx4 a[204:207], v5, s[56:59], s77 offen offset:3072 sc1
s_add_u32 s77, s84, 176128
buffer_load_dwordx4 a[208:211], v5, s[56:59], s77 offen offset:0 sc1
buffer_load_dwordx4 a[212:215], v5, s[56:59], s77 offen offset:1024 sc1
buffer_load_dwordx4 a[216:219], v5, s[56:59], s77 offen offset:2048 sc1
s_add_u32 s77, s84, 229376
buffer_load_dwordx4 a[220:223], v5, s[56:59], s77 offen offset:0 sc1
buffer_load_dwordx4 a[224:227], v5, s[56:59], s77 offen offset:1024 sc1
buffer_load_dwordx4 a[228:231], v5, s[56:59], s77 offen offset:2048 sc1
buffer_load_dwordx4 a[232:235], v5, s[56:59], s77 offen offset:3072 sc1
s_add_u32 s77, s84, 233472
buffer_load_dwordx4 a[236:239], v5, s[56:59], s77 offen offset:0 sc1
buffer_load_dwordx4 a[240:243], v5, s[56:59], s77 offen offset:1024 sc1
buffer_load_dwordx4 a[244:247], v5, s[56:59], s77 offen offset:2048 sc1
s_mov_b32 s100, 0
buffer_load_dwordx2 v[56:57], v230, s[56:59], 0 offen sc1
s_waitcnt vmcnt(0)
v_cmp_ne_u64 vcc, s[68:69], v[56:57]
s_cbranch_vccnz Lsp_31
Lsd_32:
Lg2:
buffer_load_dwordx4 v[160:163], v5, s[56:59], s18 offen offset:0 sc1
buffer_load_dwordx4 v[164:167], v5, s[56:59], s18 offen offset:1024 sc1
buffer_load_dwordx4 v[168:171], v5, s[56:59], s18 offen offset:2048 sc1
buffer_load_dwordx4 v[172:175], v5, s[56:59], s18 offen offset:3072 sc1
s_add_u32 s18, s18, 4096
buffer_load_dwordx4 v[176:179], v5, s[56:59], s18 offen offset:0 sc1
buffer_load_dwordx4 v[180:183], v5, s[56:59], s18 offen offset:1024 sc1
buffer_load_dwordx4 v[184:187], v5, s[56:59], s18 offen offset:2048 sc1
buffer_load_dwordx4 v[188:191], v5, s[56:59], s19 offen offset:0 sc1
buffer_load_dwordx4 v[192:195], v5, s[56:59], s19 offen offset:1024 sc1
buffer_load_dwordx4 v[196:199], v5, s[56:59], s19 offen offset:2048 sc1
buffer_load_dwordx4 v[200:203], v5, s[56:59], s19 offen offset:3072 sc1
s_add_u32 s19, s19, 4096
buffer_load_dwordx4 v[204:207], v5, s[56:59], s19 offen offset:0 sc1
buffer_load_dwordx4 v[208:211], v5, s[56:59], s19 offen offset:1024 sc1
buffer_load_dwordx4 v[212:215], v5, s[56:59], s19 offen offset:2048 sc1
buffer_load_dwordx4 v[216:219], v5, s[56:59], s20 offen offset:0 sc1
Lg2b:
buffer_load_dwordx4 v[220:223], v5, s[56:59], s20 offen offset:1024 sc1
s_waitcnt vmcnt(15)
v_mfma_f32_16x16x32_bf16 v[64:67], a[108:111], v[160:163], 0
v_mfma_f32_16x16x32_bf16 v[68:71], a[136:139], v[160:163], 0
v_mfma_f32_16x16x32_bf16 v[72:75], a[164:167], v[160:163], 0
v_mfma_f32_16x16x32_bf16 v[76:79], a[192:195], v[160:163], 0
v_mfma_f32_16x16x32_bf16 v[80:83], a[220:223], v[160:163], 0
buffer_load_dwordx4 v[160:163], v5, s[56:59], s20 offen offset:2048 sc1
s_waitcnt vmcnt(15)
v_mfma_f32_16x16x32_bf16 v[64:67], a[112:115], v[164:167], v[64:67]
v_mfma_f32_16x16x32_bf16 v[68:71], a[140:143], v[164:167], v[68:71]
v_mfma_f32_16x16x32_bf16 v[72:75], a[168:171], v[164:167], v[72:75]
v_mfma_f32_16x16x32_bf16 v[76:79], a[196:199], v[164:167], v[76:79]
v_mfma_f32_16x16x32_bf16 v[80:83], a[224:227], v[164:167], v[80:83]
buffer_load_dwordx4 v[164:167], v5, s[56:59], s20 offen offset:3072 sc1
s_waitcnt vmcnt(15)
v_mfma_f32_16x16x32_bf16 v[64:67], a[116:119], v[168:171], v[64:67]
v_mfma_f32_16x16x32_bf16 v[68:71], a[144:147], v[168:171], v[68:71]
v_mfma_f32_16x16x32_bf16 v[72:75], a[172:175], v[168:171], v[72:75]
v_mfma_f32_16x16x32_bf16 v[76:79], a[200:203], v[168:171], v[76:79]
v_mfma_f32_16x16x32_bf16 v[80:83], a[228:231], v[168:171], v[80:83]
s_add_u32 s20, s20, 4096
buffer_load_dwordx4 v[168:171], v5, s[56:59], s20 offen offset:0 sc1
s_waitcnt vmcnt(15)
v_mfma_f32_16x16x32_bf16 v[64:67], a[120:123], v[172:175], v[64:67]
v_mfma_f32_16x16x32_bf16 v[68:71], a[148:151], v[172:175], v[68:71]
v_mfma_f32_16x16x32_bf16 v[72:75], a[176:179], v[172:175], v[72:75]
v_mfma_f32_16x16x32_bf16 v[76:79], a[204:207], v[172:175], v[76:79]
v_mfma_f32_16x16x32_bf16 v[80:83], a[232:235], v[172:175], v[80:83]
buffer_load_dwordx4 v[172:175], v5, s[56:59], s20 offen offset:1024 sc1
s_waitcnt vmcnt(15)
v_mfma_f32_16x16x32_bf16 v[64:67], a[124:127], v[176:179], v[64:67]
v_mfma_f32_16x16x32_bf16 v[68:71], a[152:155], v[176:179], v[68:71]
v_mfma_f32_16x16x32_bf16 v[72:75], a[180:183], v[176:179], v[72:75]
v_mfma_f32_16x16x32_bf16 v[76:79], a[208:211], v[176:179], v[76:79]
v_mfma_f32_16x16x32_bf16 v[80:83], a[236:239], v[176:179], v[80:83]
buffer_load_dwordx4 v[176:179], v5, s[56:59], s20 offen offset:2048 sc1
s_waitcnt vmcnt(15)
v_mfma_f32_16x16x32_bf16 v[64:67], a[128:131], v[180:183], v[64:67]
v_mfma_f32_16x16x32_bf16 v[68:71], a[156:159], v[180:183], v[68:71]
v_mfma_f32_16x16x32_bf16 v[72:75], a[184:187], v[180:183], v[72:75]
v_mfma_f32_16x16x32_bf16 v[76:79], a[212:215], v[180:183], v[76:79]
v_mfma_f32_16x16x32_bf16 v[80:83], a[240:243], v[180:183], v[80:83]
buffer_load_dwordx4 v[180:183], v5, s[56:59], s21 offen offset:0 sc1
s_waitcnt vmcnt(15)
v_mfma_f32_16x16x32_bf16 v[64:67], a[132:135], v[184:187], v[64:67]
v_mfma_f32_16x16x32_bf16 v[68:71], a[160:163], v[184:187], v[68:71]
v_mfma_f32_16x16x32_bf16 v[72:75], a[188:191], v[184:187], v[72:75]
v_mfma_f32_16x16x32_bf16 v[76:79], a[216:219], v[184:187], v[76:79]
v_mfma_f32_16x16x32_bf16 v[80:83], a[244:247], v[184:187], v[80:83]
buffer_load_dwordx4 v[184:187], v5, s[56:59], s21 offen offset:1024 sc1
s_waitcnt vmcnt(15)
v_mfma_f32_16x16x32_bf16 v[84:87], a[108:111], v[188:191], 0
v_mfma_f32_16x16x32_bf16 v[88:91], a[136:139], v[188:191], 0
v_mfma_f32_16x16x32_bf16 v[92:95], a[164:167], v[188:191], 0
ds_write_b128 v231, v[64:67] offset:0
v_mfma_f32_16x16x32_bf16 v[96:99], a[192:195], v[188:191], 0
v_mfma_f32_16x16x32_bf16 v[100:103], a[220:223], v[188:191], 0
buffer_load_dwordx4 v[188:191], v5, s[56:59], s21 offen offset:2048 sc1
s_waitcnt vmcnt(15)
v_mfma_f32_16x16x32_bf16 v[84:87], a[112:115], v[192:195], v[84:87]
v_mfma_f32_16x16x32_bf16 v[88:91], a[140:143], v[192:195], v[88:91]
ds_write_b128 v231, v[68:71] offset:1024
v_mfma_f32_16x16x32_bf16 v[92:95], a[168:171], v[192:195], v[92:95]
v_mfma_f32_16x16x32_bf16 v[96:99], a[196:199], v[192:195], v[96:99]
v_mfma_f32_16x16x32_bf16 v[100:103], a[224:227], v[192:195], v[100:103]
buffer_load_dwordx4 v[192:195], v5, s[56:59], s21 offen offset:3072 sc1
s_waitcnt vmcnt(15)
v_mfma_f32_16x16x32_bf16 v[84:87], a[116:119], v[196:199], v[84:87]
ds_write_b128 v231, v[72:75] offset:2048
v_mfma_f32_16x16x32_bf16 v[88:91], a[144:147], v[196:199], v[88:91]
v_mfma_f32_16x16x32_bf16 v[92:95], a[172:175], v[196:199], v[92:95]
v_mfma_f32_16x16x32_bf16 v[96:99], a[200:203], v[196:199], v[96:99]
v_mfma_f32_16x16x32_bf16 v[100:103], a[228:231], v[196:199], v[100:103]
ds_write_b128 v231, v[76:79] offset:3072
s_add_u32 s21, s21, 4096
buffer_load_dwordx4 v[196:199], v5, s[56:59], s21 offen offset:0 sc1
s_waitcnt vmcnt(15)
s_waitcnt vmcnt(11)
s_mov_b64 exec, 1
buffer_store_dwordx2 v[60:61], off, s[64:67], s100 sc1
s_mov_b64 exec, -1
v_mfma_f32_16x16x32_bf16 v[84:87], a[120:123], v[200:203], v[84:87]
v_mfma_f32_16x16x32_bf16 v[88:91], a[148:151], v[200:203], v[88:91]
v_mfma_f32_16x16x32_bf16 v[92:95], a[176:179], v[200:203], v[92:95]
v_mfma_f32_16x16x32_bf16 v[96:99], a[204:207], v[200:203], v[96:99]
ds_write_b128 v231, v[80:83] offset:4096
v_mfma_f32_16x16x32_bf16 v[100:103], a[232:235], v[200:203], v[100:103]
buffer_load_dwordx4 v[200:203], v5, s[56:59], s21 offen offset:1024 sc1
v_mfma_f32_16x16x32_bf16 v[84:87], a[124:127], v[204:207], v[84:87]
v_mfma_f32_16x16x32_bf16 v[88:91], a[152:155], v[204:207], v[88:91]
v_mfma_f32_16x16x32_bf16 v[92:95], a[180:183], v[204:207], v[92:95]
v_mfma_f32_16x16x32_bf16 v[96:99], a[208:211], v[204:207], v[96:99]
v_mfma_f32_16x16x32_bf16 v[100:103], a[236:239], v[204:207], v[100:103]
buffer_load_dwordx4 v[204:207], v5, s[56:59], s21 offen offset:2048 sc1
v_mfma_f32_16x16x32_bf16 v[84:87], a[128:131], v[208:211], v[84:87]
v_mfma_f32_16x16x32_bf16 v[88:91], a[156:159], v[208:211], v[88:91]
v_mfma_f32_16x16x32_bf16 v[92:95], a[184:187], v[208:211], v[92:95]
v_mfma_f32_16x16x32_bf16 v[96:99], a[212:215], v[208:211], v[96:99]
v_mfma_f32_16x16x32_bf16 v[100:103], a[240:243], v[208:211], v[100:103]
buffer_load_dwordx4 v[208:211], v5, s[56:59], s22 offen offset:0 sc1
v_mfma_f32_16x16x32_bf16 v[84:87], a[132:135], v[212:215], v[84:87]
v_mfma_f32_16x16x32_bf16 v[88:91], a[160:163], v[212:215], v[88:91]
v_mfma_f32_16x16x32_bf16 v[92:95], a[188:191], v[212:215], v[92:95]
v_mfma_f32_16x16x32_bf16 v[96:99], a[216:219], v[212:215], v[96:99]
v_mfma_f32_16x16x32_bf16 v[100:103], a[244:247], v[212:215], v[100:103]
buffer_load_dwordx4 v[212:215], v5, s[56:59], s22 offen offset:1024 sc1
v_mfma_f32_16x16x32_bf16 v[64:67], a[108:111], v[216:219], 0
v_mfma_f32_16x16x32_bf16 v[68:71], a[136:139], v[216:219], 0
v_mfma_f32_16x16x32_bf16 v[72:75], a[164:167], v[216:219], 0
ds_write_b128 v232, v[84:87] offset:5120
v_mfma_f32_16x16x32_bf16 v[76:79], a[192:195], v[216:219], 0
v_mfma_f32_16x16x32_bf16 v[80:83], a[220:223], v[216:219], 0
buffer_load_dwordx4 v[216:219], v5, s[56:59], s22 offen offset:2048 sc1
s_waitcnt vmcnt(16)
v_mfma_f32_16x16x32_bf16 v[64:67], a[112:115], v[220:223], v[64:67]
v_mfma_f32_16x16x32_bf16 v[68:71], a[140:143], v[220:223], v[68:71]
ds_write_b128 v232, v[88:91] offset:6144
v_mfma_f32_16x16x32_bf16 v[72:75], a[168:171], v[220:223], v[72:75]
v_mfma_f32_16x16x32_bf16 v[76:79], a[196:199], v[220:223], v[76:79]
v_mfma_f32_16x16x32_bf16 v[80:83], a[224:227], v[220:223], v[80:83]
buffer_load_dwordx4 v[220:223], v5, s[56:59], s22 offen offset:3072 sc1
s_waitcnt vmcnt(16)
v_mfma_f32_16x16x32_bf16 v[64:67], a[116:119], v[160:163], v[64:67]
ds_write_b128 v232, v[92:95] offset:7168
v_mfma_f32_16x16x32_bf16 v[68:71], a[144:147], v[160:163], v[68:71]
v_mfma_f32_16x16x32_bf16 v[72:75], a[172:175], v[160:163], v[72:75]
v_mfma_f32_16x16x32_bf16 v[76:79], a[200:203], v[160:163], v[76:79]
v_mfma_f32_16x16x32_bf16 v[80:83], a[228:231], v[160:163], v[80:83]
ds_write_b128 v232, v[96:99] offset:8192
s_add_u32 s22, s22, 4096
buffer_load_dwordx4 v[160:163], v5, s[56:59], s22 offen offset:0 sc1
s_waitcnt vmcnt(16)
v_mfma_f32_16x16x32_bf16 v[64:67], a[120:123], v[164:167], v[64:67]
v_mfma_f32_16x16x32_bf16 v[68:71], a[148:151], v[164:167], v[68:71]
v_mfma_f32_16x16x32_bf16 v[72:75], a[176:179], v[164:167], v[72:75]
v_mfma_f32_16x16x32_bf16 v[76:79], a[204:207], v[164:167], v[76:79]
ds_write_b128 v232, v[100:103] offset:9216
v_mfma_f32_16x16x32_bf16 v[80:83], a[232:235], v[164:167], v[80:83]
buffer_load_dwordx4 v[164:167], v5, s[56:59], s22 offen offset:1024 sc1
s_waitcnt vmcnt(16)
v_mfma_f32_16x16x32_bf16 v[64:67], a[124:127], v[168:171], v[64:67]
v_mfma_f32_16x16x32_bf16 v[68:71], a[152:155], v[168:171], v[68:71]
v_mfma_f32_16x16x32_bf16 v[72:75], a[180:183], v[168:171], v[72:75]
v_mfma_f32_16x16x32_bf16 v[76:79], a[208:211], v[168:171], v[76:79]
v_mfma_f32_16x16x32_bf16 v[80:83], a[236:239], v[168:171], v[80:83]
buffer_load_dwordx4 v[168:171], v5, s[56:59], s22 offen offset:2048 sc1
s_waitcnt vmcnt(16)
v_mfma_f32_16x16x32_bf16 v[64:67], a[128:131], v[172:175], v[64:67]
v_mfma_f32_16x16x32_bf16 v[68:71], a[156:159], v[172:175], v[68:71]
v_mfma_f32_16x16x32_bf16 v[72:75], a[184:187], v[172:175], v[72:75]
v_mfma_f32_16x16x32_bf16 v[76:79], a[212:215], v[172:175], v[76:79]
v_mfma_f32_16x16x32_bf16 v[80:83], a[240:243], v[172:175], v[80:83]
buffer_load_dwordx4 v[172:175], v5, s[56:59], s23 offen offset:0 sc1
s_waitcnt vmcnt(16)
v_mfma_f32_16x16x32_bf16 v[64:67], a[132:135], v[176:179], v[64:67]
v_mfma_f32_16x16x32_bf16 v[68:71], a[160:163], v[176:179], v[68:71]
v_mfma_f32_16x16x32_bf16 v[72:75], a[188:191], v[176:179], v[72:75]
v_mfma_f32_16x16x32_bf16 v[76:79], a[216:219], v[176:179], v[76:79]
v_mfma_f32_16x16x32_bf16 v[80:83], a[244:247], v[176:179], v[80:83]
buffer_load_dwordx4 v[176:179], v5, s[56:59], s23 offen offset:1024 sc1
s_waitcnt vmcnt(16)
v_mfma_f32_16x16x32_bf16 v[84:87], a[108:111], v[180:183], 0
v_mfma_f32_16x16x32_bf16 v[88:91], a[136:139], v[180:183], 0
ds_write_b128 v233, v[64:67] offset:10240
v_mfma_f32_16x16x32_bf16 v[92:95], a[164:167], v[180:183], 0
ds_write_b128 v233, v[68:71] offset:11264
v_mfma_f32_16x16x32_bf16 v[96:99], a[192:195], v[180:183], 0
ds_write_b128 v233, v[72:75] offset:12288
v_mfma_f32_16x16x32_bf16 v[100:103], a[220:223], v[180:183], 0
ds_write_b128 v233, v[76:79] offset:13312
buffer_load_dwordx4 v[180:183], v5, s[56:59], s23 offen offset:2048 sc1
s_waitcnt vmcnt(16)
v_mfma_f32_16x16x32_bf16 v[84:87], a[112:115], v[184:187], v[84:87]
ds_write_b128 v233, v[80:83] offset:14336
v_mfma_f32_16x16x32_bf16 v[88:91], a[140:143], v[184:187], v[88:91]
v_mfma_f32_16x16x32_bf16 v[92:95], a[168:171], v[184:187], v[92:95]
v_mfma_f32_16x16x32_bf16 v[96:99], a[196:199], v[184:187], v[96:99]
v_mfma_f32_16x16x32_bf16 v[100:103], a[224:227], v[184:187], v[100:103]
buffer_load_dwordx4 v[184:187], v5, s[56:59], s23 offen offset:3072 sc1
s_waitcnt vmcnt(16)
v_mfma_f32_16x16x32_bf16 v[84:87], a[116:119], v[188:191], v[84:87]
v_mfma_f32_16x16x32_bf16 v[88:91], a[144:147], v[188:191], v[88:91]
v_mfma_f32_16x16x32_bf16 v[92:95], a[172:175], v[188:191], v[92:95]
v_mfma_f32_16x16x32_bf16 v[96:99], a[200:203], v[188:191], v[96:99]
v_mfma_f32_16x16x32_bf16 v[100:103], a[228:231], v[188:191], v[100:103]
s_waitcnt lgkmcnt(0)
s_barrier
s_add_u32 s23, s23, 4096
buffer_load_dwordx4 v[188:191], v5, s[56:59], s23 offen offset:0 sc1
s_waitcnt vmcnt(16)
v_mfma_f32_16x16x32_bf16 v[84:87], a[120:123], v[192:195], v[84:87]
ds_read_b128 v[104:107], v234 offset:0
ds_read_b128 v[124:127], v234 offset:5120
v_mfma_f32_16x16x32_bf16 v[88:91], a[148:151], v[192:195], v[88:91]
ds_read_b128 v[8:11], v234 offset:10240
ds_read_b128 v[108:111], v234 offset:1024
v_mfma_f32_16x16x32_bf16 v[92:95], a[176:179], v[192:195], v[92:95]
ds_read_b128 v[128:131], v234 offset:6144
ds_read_b128 v[12:15], v234 offset:11264
v_mfma_f32_16x16x32_bf16 v[96:99], a[204:207], v[192:195], v[96:99]
ds_read_b128 v[112:115], v234 offset:2048
ds_read_b128 v[132:135], v234 offset:7168
v_mfma_f32_16x16x32_bf16 v[100:103], a[232:235], v[192:195], v[100:103]
ds_read_b128 v[16:19], v234 offset:12288
buffer_load_dwordx4 v[192:195], v5, s[56:59], s23 offen offset:1024 sc1
s_waitcnt vmcnt(16)
v_mfma_f32_16x16x32_bf16 v[84:87], a[124:127], v[196:199], v[84:87]
ds_read_b128 v[116:119], v234 offset:3072
ds_read_b128 v[136:139], v234 offset:8192
v_mfma_f32_16x16x32_bf16 v[88:91], a[152:155], v[196:199], v[88:91]
ds_read_b128 v[20:23], v234 offset:13312
ds_read_b128 v[120:123], v234 offset:4096
v_mfma_f32_16x16x32_bf16 v[92:95], a[180:183], v[196:199], v[92:95]
ds_read_b128 v[140:143], v234 offset:9216
ds_read_b128 v[24:27], v234 offset:14336
v_mfma_f32_16x16x32_bf16 v[96:99], a[208:211], v[196:199], v[96:99]
s_waitcnt lgkmcnt(12)
v_add_f32_e64 v104, v104, v124
v_mfma_f32_16x16x32_bf16 v[100:103], a[236:239], v[196:199], v[100:103]
v_add_f32_e64 v104, v104, v8
buffer_load_dwordx4 v[196:199], v5, s[56:59], s23 offen offset:2048 sc1
s_waitcnt vmcnt(15)
v_mfma_f32_16x16x32_bf16 v[84:87], a[128:131], v[200:203], v[84:87]
v_add_f32 v105, v105, v125
v_add_f32_e64 v105, v105, v9
v_mfma_f32_16x16x32_bf16 v[88:91], a[156:159], v[200:203], v[88:91]
v_add_f32 v106, v106, v126
v_add_f32 v106, v106, v10
v_mfma_f32_16x16x32_bf16 v[92:95], a[184:187], v[200:203], v[92:95]
v_add_f32 v107, v107, v127
v_add_f32 v107, v107, v11
v_mfma_f32_16x16x32_bf16 v[96:99], a[212:215], v[200:203], v[96:99]
s_waitcnt lgkmcnt(9)
v_add_f32 v108, v108, v128
v_mfma_f32_16x16x32_bf16 v[100:103], a[240:243], v[200:203], v[100:103]
v_add_f32_e64 v108, v108, v12
buffer_load_dwordx4 v[200:203], v5, s[56:59], s24 offen offset:0 sc1
s_waitcnt vmcnt(15)
v_mfma_f32_16x16x32_bf16 v[84:87], a[132:135], v[204:207], v[84:87]
v_add_f32 v109, v109, v129
v_add_f32_e64 v109, v109, v13
v_mfma_f32_16x16x32_bf16 v[88:91], a[160:163], v[204:207], v[88:91]
v_add_f32 v110, v110, v130
v_add_f32 v110, v110, v14
v_mfma_f32_16x16x32_bf16 v[92:95], a[188:191], v[204:207], v[92:95]
v_add_f32 v111, v111, v131
v_add_f32 v111, v111, v15
v_mfma_f32_16x16x32_bf16 v[96:99], a[216:219], v[204:207], v[96:99]
s_waitcnt lgkmcnt(6)
v_add_f32 v112, v112, v132
v_mfma_f32_16x16x32_bf16 v[100:103], a[244:247], v[204:207], v[100:103]
v_add_f32_e64 v112, v112, v16
buffer_load_dwordx4 v[204:207], v5, s[56:59], s24 offen offset:1024 sc1
s_waitcnt vmcnt(15)
v_mfma_f32_16x16x32_bf16 v[64:67], a[108:111], v[208:211], 0
v_add_f32 v113, v113, v133
v_add_f32_e64 v113, v113, v17
v_mfma_f32_16x16x32_bf16 v[68:71], a[136:139], v[208:211], 0
v_add_f32 v114, v114, v134
v_add_f32 v114, v114, v18
v_mfma_f32_16x16x32_bf16 v[72:75], a[164:167], v[208:211], 0
v_add_f32 v115, v115, v135
v_add_f32 v115, v115, v19
v_mfma_f32_16x16x32_bf16 v[76:79], a[192:195], v[208:211], 0
s_waitcnt lgkmcnt(3)
v_add_f32 v116, v116, v136
v_mfma_f32_16x16x32_bf16 v[80:83], a[220:223], v[208:211], 0
v_add_f32 v116, v116, v20
v_add_f32 v117, v117, v137
buffer_load_dwordx4 v[208:211], v5, s[56:59], s24 offen offset:2048 sc1
s_waitcnt vmcnt(15)
v_mfma_f32_16x16x32_bf16 v[64:67], a[112:115], v[212:215], v[64:67]
v_add_f32 v117, v117, v21
v_add_f32_e64 v118, v118, v138
v_mfma_f32_16x16x32_bf16 v[68:71], a[140:143], v[212:215], v[68:71]
v_add_f32 v118, v118, v22
v_add_f32 v119, v119, v139
v_mfma_f32_16x16x32_bf16 v[72:75], a[168:171], v[212:215], v[72:75]
v_add_f32 v119, v119, v23
s_waitcnt lgkmcnt(0)
v_mfma_f32_16x16x32_bf16 v[76:79], a[196:199], v[212:215], v[76:79]
v_add_f32 v120, v120, v140
v_add_f32 v120, v120, v24
v_mfma_f32_16x16x32_bf16 v[80:83], a[224:227], v[212:215], v[80:83]
v_add_f32 v121, v121, v141
v_add_f32 v121, v121, v25
buffer_load_dwordx4 v[212:215], v5, s[56:59], s24 offen offset:3072 sc1
s_waitcnt vmcnt(15)
v_mfma_f32_16x16x32_bf16 v[64:67], a[116:119], v[216:219], v[64:67]
v_add_f32 v122, v122, v142
v_add_f32_e64 v122, v122, v26
v_mfma_f32_16x16x32_bf16 v[68:71], a[144:147], v[216:219], v[68:71]
v_add_f32 v123, v123, v143
v_add_f32 v123, v123, v27
v_mfma_f32_16x16x32_bf16 v[72:75], a[172:175], v[216:219], v[72:75]
v_add_f32 v104, v104, v84
v_add_f32 v105, v105, v85
v_mfma_f32_16x16x32_bf16 v[76:79], a[200:203], v[216:219], v[76:79]
v_cvt_pk_bf16_f32 v8, v104, v105
v_add_f32_e64 v106, v106, v86
v_mfma_f32_16x16x32_bf16 v[80:83], a[228:231], v[216:219], v[80:83]
v_add_f32_e64 v107, v107, v87
v_cvt_pk_bf16_f32 v9, v106, v107
s_add_u32 s24, s24, 4096
buffer_load_dwordx4 v[216:219], v5, s[56:59], s24 offen offset:0 sc1
s_waitcnt vmcnt(15)
v_mfma_f32_16x16x32_bf16 v[64:67], a[120:123], v[220:223], v[64:67]
v_add_f32 v108, v108, v88
v_add_f32_e64 v109, v109, v89
v_mfma_f32_16x16x32_bf16 v[68:71], a[148:151], v[220:223], v[68:71]
v_cvt_pk_bf16_f32 v10, v108, v109
v_add_f32_e64 v110, v110, v90
v_mfma_f32_16x16x32_bf16 v[72:75], a[176:179], v[220:223], v[72:75]
v_add_f32_e64 v111, v111, v91
v_cvt_pk_bf16_f32 v11, v110, v111
v_mfma_f32_16x16x32_bf16 v[76:79], a[204:207], v[220:223], v[76:79]
buffer_store_dwordx4 v[8:11], v5, s[56:59], s29 offen sc1
v_add_f32_e64 v112, v112, v92
v_mfma_f32_16x16x32_bf16 v[80:83], a[232:235], v[220:223], v[80:83]
v_add_f32_e64 v113, v113, v93
v_cvt_pk_bf16_f32 v12, v112, v113
buffer_load_dwordx4 v[220:223], v5, s[56:59], s24 offen offset:1024 sc1
s_waitcnt vmcnt(16)
v_mfma_f32_16x16x32_bf16 v[64:67], a[124:127], v[160:163], v[64:67]
v_add_f32 v114, v114, v94
v_add_f32_e64 v115, v115, v95
v_mfma_f32_16x16x32_bf16 v[68:71], a[152:155], v[160:163], v[68:71]
v_cvt_pk_bf16_f32 v13, v114, v115
v_add_f32_e64 v116, v116, v96
v_mfma_f32_16x16x32_bf16 v[72:75], a[180:183], v[160:163], v[72:75]
v_add_f32_e64 v117, v117, v97
v_cvt_pk_bf16_f32 v14, v116, v117
v_mfma_f32_16x16x32_bf16 v[76:79], a[208:211], v[160:163], v[76:79]
v_add_f32 v118, v118, v98
v_add_f32 v119, v119, v99
v_mfma_f32_16x16x32_bf16 v[80:83], a[236:239], v[160:163], v[80:83]
v_cvt_pk_bf16_f32 v15, v118, v119
buffer_store_dwordx4 v[12:15], v5, s[56:59], s29 offen offset:1024 sc1
buffer_load_dwordx4 v[160:163], v5, s[56:59], s24 offen offset:2048 sc1
s_waitcnt vmcnt(17)
v_mfma_f32_16x16x32_bf16 v[64:67], a[128:131], v[164:167], v[64:67]
v_add_f32 v120, v120, v100
v_add_f32_e64 v121, v121, v101
v_mfma_f32_16x16x32_bf16 v[68:71], a[156:159], v[164:167], v[68:71]
v_cvt_pk_bf16_f32 v16, v120, v121
v_add_f32_e64 v122, v122, v102
v_mfma_f32_16x16x32_bf16 v[72:75], a[184:187], v[164:167], v[72:75]
v_add_f32_e64 v123, v123, v103
v_cvt_pk_bf16_f32 v17, v122, v123
v_mfma_f32_16x16x32_bf16 v[76:79], a[212:215], v[164:167], v[76:79]
buffer_store_dwordx2 v[16:17], v240, s[56:59], s29 offen offset:2048 sc1
v_add_u32 v231, 61440, v231
v_mfma_f32_16x16x32_bf16 v[80:83], a[240:243], v[164:167], v[80:83]
v_add_u32 v232, 61440, v232
v_add_u32 v233, 61440, v233
buffer_load_dwordx4 v[164:167], v5, s[56:59], s25 offen offset:0 sc1
s_waitcnt vmcnt(18)
v_mfma_f32_16x16x32_bf16 v[64:67], a[132:135], v[168:171], v[64:67]
v_add_u32 v234, 61440, v234
v_mfma_f32_16x16x32_bf16 v[68:71], a[160:163], v[168:171], v[68:71]
v_mfma_f32_16x16x32_bf16 v[72:75], a[188:191], v[168:171], v[72:75]
v_mfma_f32_16x16x32_bf16 v[76:79], a[216:219], v[168:171], v[76:79]
v_mfma_f32_16x16x32_bf16 v[80:83], a[244:247], v[168:171], v[80:83]
buffer_load_dwordx4 v[168:171], v5, s[56:59], s25 offen offset:1024 sc1
s_waitcnt vmcnt(18)
v_mfma_f32_16x16x32_bf16 v[84:87], a[108:111], v[172:175], 0
v_mfma_f32_16x16x32_bf16 v[88:91], a[136:139], v[172:175], 0
v_mfma_f32_16x16x32_bf16 v[92:95], a[164:167], v[172:175], 0
ds_write_b128 v231, v[64:67] offset:0
v_mfma_f32_16x16x32_bf16 v[96:99], a[192:195], v[172:175], 0
v_mfma_f32_16x16x32_bf16 v[100:103], a[220:223], v[172:175], 0
buffer_load_dwordx4 v[172:175], v5, s[56:59], s25 offen offset:2048 sc1
s_waitcnt vmcnt(18)
v_mfma_f32_16x16x32_bf16 v[84:87], a[112:115], v[176:179], v[84:87]
v_mfma_f32_16x16x32_bf16 v[88:91], a[140:143], v[176:179], v[88:91]
ds_write_b128 v231, v[68:71] offset:1024
v_mfma_f32_16x16x32_bf16 v[92:95], a[168:171], v[176:179], v[92:95]
v_mfma_f32_16x16x32_bf16 v[96:99], a[196:199], v[176:179], v[96:99]
v_mfma_f32_16x16x32_bf16 v[100:103], a[224:227], v[176:179], v[100:103]
buffer_load_dwordx4 v[176:179], v5, s[56:59], s25 offen offset:3072 sc1
s_waitcnt vmcnt(18)
v_mfma_f32_16x16x32_bf16 v[84:87], a[116:119], v[180:183], v[84:87]
ds_write_b128 v231, v[72:75] offset:2048
v_mfma_f32_16x16x32_bf16 v[88:91], a[144:147], v[180:183], v[88:91]
v_mfma_f32_16x16x32_bf16 v[92:95], a[172:175], v[180:183], v[92:95]
v_mfma_f32_16x16x32_bf16 v[96:99], a[200:203], v[180:183], v[96:99]
v_mfma_f32_16x16x32_bf16 v[100:103], a[228:231], v[180:183], v[100:103]
ds_write_b128 v231, v[76:79] offset:3072
s_add_u32 s25, s25, 4096
buffer_load_dwordx4 v[180:183], v5, s[56:59], s25 offen offset:0 sc1
s_waitcnt vmcnt(18)
v_mfma_f32_16x16x32_bf16 v[84:87], a[120:123], v[184:187], v[84:87]
v_mfma_f32_16x16x32_bf16 v[88:91], a[148:151], v[184:187], v[88:91]
v_mfma_f32_16x16x32_bf16 v[92:95], a[176:179], v[184:187], v[92:95]
v_mfma_f32_16x16x32_bf16 v[96:99], a[204:207], v[184:187], v[96:99]
ds_write_b128 v231, v[80:83] offset:4096
v_mfma_f32_16x16x32_bf16 v[100:103], a[232:235], v[184:187], v[100:103]
s_waitcnt vmcnt(5)
s_mov_b64 exec, 1
buffer_store_dwordx2 v[60:61], off, s[56:59], s35 sc1
s_mov_b64 exec, -1
buffer_load_dwordx4 v[184:187], v5, s[56:59], s25 offen offset:1024 sc1
v_mfma_f32_16x16x32_bf16 v[84:87], a[124:127], v[188:191], v[84:87]
v_mfma_f32_16x16x32_bf16 v[88:91], a[152:155], v[188:191], v[88:91]
v_mfma_f32_16x16x32_bf16 v[92:95], a[180:183], v[188:191], v[92:95]
v_mfma_f32_16x16x32_bf16 v[96:99], a[208:211], v[188:191], v[96:99]
v_mfma_f32_16x16x32_bf16 v[100:103], a[236:239], v[188:191], v[100:103]
buffer_load_dwordx4 v[188:191], v5, s[56:59], s25 offen offset:2048 sc1
v_mfma_f32_16x16x32_bf16 v[84:87], a[128:131], v[192:195], v[84:87]
v_mfma_f32_16x16x32_bf16 v[88:91], a[156:159], v[192:195], v[88:91]
v_mfma_f32_16x16x32_bf16 v[92:95], a[184:187], v[192:195], v[92:95]
v_mfma_f32_16x16x32_bf16 v[96:99], a[212:215], v[192:195], v[96:99]
v_mfma_f32_16x16x32_bf16 v[100:103], a[240:243], v[192:195], v[100:103]
s_or_b32 s73, s2, s3
s_cmp_lg_u32 s73, 0
s_cbranch_scc1 Lnoep0
v_min_u32 v6, 13, v2
v_lshlrev_b32_e64 v6, 7, v6
v_lshl_add_u32 v6, v3, 12, v6
v_lshlrev_b32_e64 v7, 6, v1
s_mov_b32 s73, 32768
buffer_load_dwordx2 v[48:49], v6, s[56:59], s73 offen sc1
s_mov_b32 s73, 49152
buffer_load_dwordx2 v[50:51], v6, s[56:59], s73 offen sc1
s_mov_b32 s73, 65536
buffer_load_dwordx2 v[52:53], v6, s[56:59], s73 offen sc1
s_mov_b32 s73, 81920
buffer_load_dwordx2 v[54:55], v6, s[56:59], s73 offen sc1
s_mov_b32 s73, 16384
buffer_load_dwordx2 v[62:63], v7, s[56:59], s73 offen sc1
s_mov_b32 s73, 20480
buffer_load_dwordx2 v[158:159], v7, s[56:59], s73 offen sc1
Lnoep0:
v_mfma_f32_16x16x32_bf16 v[84:87], a[132:135], v[196:199], v[84:87]
v_mfma_f32_16x16x32_bf16 v[88:91], a[160:163], v[196:199], v[88:91]
v_mfma_f32_16x16x32_bf16 v[92:95], a[188:191], v[196:199], v[92:95]
v_mfma_f32_16x16x32_bf16 v[96:99], a[216:219], v[196:199], v[96:99]
v_mfma_f32_16x16x32_bf16 v[100:103], a[244:247], v[196:199], v[100:103]
buffer_load_dwordx2 v[56:57], v235, s[56:59], 0 offen sc1
buffer_load_dword v156, v239, s[56:59], s28 offen sc1
v_mfma_f32_16x16x32_bf16 v[64:67], a[108:111], v[200:203], 0
v_mfma_f32_16x16x32_bf16 v[68:71], a[136:139], v[200:203], 0
v_mfma_f32_16x16x32_bf16 v[72:75], a[164:167], v[200:203], 0
ds_write_b128 v232, v[84:87] offset:5120
v_mfma_f32_16x16x32_bf16 v[76:79], a[192:195], v[200:203], 0
v_mfma_f32_16x16x32_bf16 v[80:83], a[220:223], v[200:203], 0
v_mfma_f32_16x16x32_bf16 v[64:67], a[112:115], v[204:207], v[64:67]
v_mfma_f32_16x16x32_bf16 v[68:71], a[140:143], v[204:207], v[68:71]
ds_write_b128 v232, v[88:91] offset:6144
v_mfma_f32_16x16x32_bf16 v[72:75], a[168:171], v[204:207], v[72:75]
v_mfma_f32_16x16x32_bf16 v[76:79], a[196:199], v[204:207], v[76:79]
v_mfma_f32_16x16x32_bf16 v[80:83], a[224:227], v[204:207], v[80:83]
v_mfma_f32_16x16x32_bf16 v[64:67], a[116:119], v[208:211], v[64:67]
ds_write_b128 v232, v[92:95] offset:7168
v_mfma_f32_16x16x32_bf16 v[68:71], a[144:147], v[208:211], v[68:71]
v_mfma_f32_16x16x32_bf16 v[72:75], a[172:175], v[208:211], v[72:75]
v_mfma_f32_16x16x32_bf16 v[76:79], a[200:203], v[208:211], v[76:79]
v_mfma_f32_16x16x32_bf16 v[80:83], a[228:231], v[208:211], v[80:83]
ds_write_b128 v232, v[96:99] offset:8192
v_mfma_f32_16x16x32_bf16 v[64:67], a[120:123], v[212:215], v[64:67]
v_mfma_f32_16x16x32_bf16 v[68:71], a[148:151], v[212:215], v[68:71]
v_mfma_f32_16x16x32_bf16 v[72:75], a[176:179], v[212:215], v[72:75]
v_mfma_f32_16x16x32_bf16 v[76:79], a[204:207], v[212:215], v[76:79]
ds_write_b128 v232, v[100:103] offset:9216
v_mfma_f32_16x16x32_bf16 v[80:83], a[232:235], v[212:215], v[80:83]
v_mfma_f32_16x16x32_bf16 v[64:67], a[124:127], v[216:219], v[64:67]
v_mfma_f32_16x16x32_bf16 v[68:71], a[152:155], v[216:219], v[68:71]
v_mfma_f32_16x16x32_bf16 v[72:75], a[180:183], v[216:219], v[72:75]
v_mfma_f32_16x16x32_bf16 v[76:79], a[208:211], v[216:219], v[76:79]
v_mfma_f32_16x16x32_bf16 v[80:83], a[236:239], v[216:219], v[80:83]
v_mfma_f32_16x16x32_bf16 v[64:67], a[128:131], v[220:223], v[64:67]
v_mfma_f32_16x16x32_bf16 v[68:71], a[156:159], v[220:223], v[68:71]
v_mfma_f32_16x16x32_bf16 v[72:75], a[184:187], v[220:223], v[72:75]
v_mfma_f32_16x16x32_bf16 v[76:79], a[212:215], v[220:223], v[76:79]
v_mfma_f32_16x16x32_bf16 v[80:83], a[240:243], v[220:223], v[80:83]
v_mfma_f32_16x16x32_bf16 v[64:67], a[132:135], v[160:163], v[64:67]
v_mfma_f32_16x16x32_bf16 v[68:71], a[160:163], v[160:163], v[68:71]
v_mfma_f32_16x16x32_bf16 v[72:75], a[188:191], v[160:163], v[72:75]
v_mfma_f32_16x16x32_bf16 v[76:79], a[216:219], v[160:163], v[76:79]
v_mfma_f32_16x16x32_bf16 v[80:83], a[244:247], v[160:163], v[80:83]
s_waitcnt vmcnt(9)
v_mfma_f32_16x16x32_bf16 v[84:87], a[108:111], v[164:167], 0
v_mfma_f32_16x16x32_bf16 v[88:91], a[136:139], v[164:167], 0
v_mfma_f32_16x16x32_bf16 v[92:95], a[164:167], v[164:167], 0
ds_write_b128 v233, v[64:67] offset:10240
v_mfma_f32_16x16x32_bf16 v[96:99], a[192:195], v[164:167], 0
v_mfma_f32_16x16x32_bf16 v[100:103], a[220:223], v[164:167], 0
ds_write_b128 v233, v[68:71] offset:11264
s_waitcnt vmcnt(1)
v_cmp_ne_u64 vcc, s[68:69], v[56:57]
s_cbranch_vccnz Lsp_33
Lsd_34:
buffer_load_dwordx4 v[144:147], v236, s[56:59], s26 offen sc1
s_add_u32 s26, s26, 33792
buffer_load_dwordx4 v[148:151], v236, s[56:59], s26 offen sc1
s_add_u32 s26, s26, 33792
s_mov_b32 exec_lo, 0xffffffff
s_mov_b32 exec_hi, 0x0
buffer_load_dwordx4 v[152:155], v236, s[56:59], s26 offen sc1
s_add_u32 s26, s26, 33792
s_mov_b64 exec, -1
buffer_load_dwordx4 v[28:31], v5, s[56:59], s34 offen sc1
buffer_load_dwordx4 v[32:35], v5, s[56:59], s34 offen offset:1024 sc1
buffer_load_dwordx2 v[36:37], v240, s[56:59], s34 offen offset:2048 sc1
v_mfma_f32_16x16x32_bf16 v[84:87], a[112:115], v[168:171], v[84:87]
v_mfma_f32_16x16x32_bf16 v[88:91], a[140:143], v[168:171], v[88:91]
ds_write_b128 v233, v[72:75] offset:12288
v_mfma_f32_16x16x32_bf16 v[92:95], a[168:171], v[168:171], v[92:95]
v_mfma_f32_16x16x32_bf16 v[96:99], a[196:199], v[168:171], v[96:99]
ds_write_b128 v233, v[76:79] offset:13312
v_mfma_f32_16x16x32_bf16 v[100:103], a[224:227], v[168:171], v[100:103]
v_mfma_f32_16x16x32_bf16 v[84:87], a[116:119], v[172:175], v[84:87]
ds_write_b128 v233, v[80:83] offset:14336
v_mfma_f32_16x16x32_bf16 v[88:91], a[144:147], v[172:175], v[88:91]
v_mfma_f32_16x16x32_bf16 v[92:95], a[172:175], v[172:175], v[92:95]
v_mfma_f32_16x16x32_bf16 v[96:99], a[200:203], v[172:175], v[96:99]
v_mfma_f32_16x16x32_bf16 v[100:103], a[228:231], v[172:175], v[100:103]
s_waitcnt lgkmcnt(0)
s_barrier
v_mfma_f32_16x16x32_bf16 v[84:87], a[120:123], v[176:179], v[84:87]
ds_read_b128 v[104:107], v234 offset:0
v_mfma_f32_16x16x32_bf16 v[88:91], a[148:151], v[176:179], v[88:91]
ds_read_b128 v[124:127], v234 offset:5120
v_mfma_f32_16x16x32_bf16 v[92:95], a[176:179], v[176:179], v[92:95]
ds_read_b128 v[8:11], v234 offset:10240
v_mfma_f32_16x16x32_bf16 v[96:99], a[204:207], v[176:179], v[96:99]
ds_read_b128 v[108:111], v234 offset:1024
v_mfma_f32_16x16x32_bf16 v[100:103], a[232:235], v[176:179], v[100:103]
ds_read_b128 v[128:131], v234 offset:6144
v_mfma_f32_16x16x32_bf16 v[84:87], a[124:127], v[180:183], v[84:87]
ds_read_b128 v[12:15], v234 offset:11264
v_mfma_f32_16x16x32_bf16 v[88:91], a[152:155], v[180:183], v[88:91]
ds_read_b128 v[112:115], v234 offset:2048
v_mfma_f32_16x16x32_bf16 v[92:95], a[180:183], v[180:183], v[92:95]
ds_read_b128 v[132:135], v234 offset:7168
v_mfma_f32_16x16x32_bf16 v[96:99], a[208:211], v[180:183], v[96:99]
ds_read_b128 v[16:19], v234 offset:12288
v_mfma_f32_16x16x32_bf16 v[100:103], a[236:239], v[180:183], v[100:103]
ds_read_b128 v[116:119], v234 offset:3072
v_mfma_f32_16x16x32_bf16 v[84:87], a[128:131], v[184:187], v[84:87]
ds_read_b128 v[136:139], v234 offset:8192
v_mfma_f32_16x16x32_bf16 v[88:91], a[156:159], v[184:187], v[88:91]
ds_read_b128 v[20:23], v234 offset:13312
v_mfma_f32_16x16x32_bf16 v[92:95], a[184:187], v[184:187], v[92:95]
ds_read_b128 v[120:123], v234 offset:4096
v_mfma_f32_16x16x32_bf16 v[96:99], a[212:215], v[184:187], v[96:99]
ds_read_b128 v[140:143], v234 offset:9216
v_mfma_f32_16x16x32_bf16 v[100:103], a[240:243], v[184:187], v[100:103]
ds_read_b128 v[24:27], v234 offset:14336
v_mfma_f32_16x16x32_bf16 v[84:87], a[132:135], v[188:191], v[84:87]
v_mfma_f32_16x16x32_bf16 v[88:91], a[160:163], v[188:191], v[88:91]
v_mfma_f32_16x16x32_bf16 v[92:95], a[188:191], v[188:191], v[92:95]
v_mfma_f32_16x16x32_bf16 v[96:99], a[216:219], v[188:191], v[96:99]
v_mfma_f32_16x16x32_bf16 v[100:103], a[244:247], v[188:191], v[100:103]
s_waitcnt vmcnt(3)
ds_write_b128 v237, v[144:147] offset:0
ds_write_b128 v237, v[148:151] offset:1280
s_mov_b32 exec_lo, 0xffffffff
s_mov_b32 exec_hi, 0x0
ds_write_b128 v237, v[152:155] offset:2560
s_mov_b64 exec, -1
s_waitcnt lgkmcnt(3)
v_pk_add_f32 v[104:105], v[104:105], v[124:125]
v_pk_add_f32 v[8:9], v[8:9], v[84:85]
v_pk_add_f32 v[106:107], v[106:107], v[126:127]
v_pk_add_f32 v[10:11], v[10:11], v[86:87]
v_pk_add_f32 v[108:109], v[108:109], v[128:129]
v_pk_add_f32 v[12:13], v[12:13], v[88:89]
v_pk_add_f32 v[110:111], v[110:111], v[130:131]
v_pk_add_f32 v[14:15], v[14:15], v[90:91]
v_pk_add_f32 v[112:113], v[112:113], v[132:133]
v_pk_add_f32 v[16:17], v[16:17], v[92:93]
v_pk_add_f32 v[114:115], v[114:115], v[134:135]
v_pk_add_f32 v[18:19], v[18:19], v[94:95]
v_pk_add_f32 v[116:117], v[116:117], v[136:137]
v_pk_add_f32 v[20:21], v[20:21], v[96:97]
v_pk_add_f32 v[118:119], v[118:119], v[138:139]
v_pk_add_f32 v[22:23], v[22:23], v[98:99]
v_pk_add_f32 v[120:121], v[120:121], v[140:141]
v_pk_add_f32 v[24:25], v[24:25], v[100:101]
v_pk_add_f32 v[122:123], v[122:123], v[142:143]
v_pk_add_f32 v[26:27], v[26:27], v[102:103]
s_waitcnt lgkmcnt(0)
s_barrier
ds_read_b64_tr_b16 v[192:193], v238 offset:0
ds_read_b64_tr_b16 v[194:195], v238 offset:2560
ds_read_b64_tr_b16 v[196:197], v238 offset:5120
ds_read_b64_tr_b16 v[198:199], v238 offset:7680
ds_read_b64_tr_b16 v[200:201], v238 offset:10240
s_waitcnt vmcnt(0)
v_mov_b32 v157, v156
v_lshlrev_b32_e64 v124, 16, v28
v_and_b32 v125, 0xffff0000, v28
v_pk_add_f32 v[104:105], v[104:105], v[8:9]
v_pk_add_f32 v[104:105], v[104:105], v[124:125]
v_lshlrev_b32_e64 v126, 16, v29
v_and_b32 v127, 0xffff0000, v29
v_pk_add_f32 v[106:107], v[106:107], v[10:11]
v_pk_add_f32 v[106:107], v[106:107], v[126:127]
v_lshlrev_b32_e64 v128, 16, v30
v_and_b32 v129, 0xffff0000, v30
v_pk_add_f32 v[108:109], v[108:109], v[12:13]
v_pk_add_f32 v[108:109], v[108:109], v[128:129]
v_lshlrev_b32_e64 v130, 16, v31
v_and_b32 v131, 0xffff0000, v31
v_pk_add_f32 v[110:111], v[110:111], v[14:15]
v_pk_add_f32 v[110:111], v[110:111], v[130:131]
v_lshlrev_b32_e64 v132, 16, v32
v_and_b32 v133, 0xffff0000, v32
v_pk_add_f32 v[112:113], v[112:113], v[16:17]
v_pk_add_f32 v[112:113], v[112:113], v[132:133]
v_lshlrev_b32_e64 v134, 16, v33
v_and_b32 v135, 0xffff0000, v33
v_pk_add_f32 v[114:115], v[114:115], v[18:19]
v_pk_add_f32 v[114:115], v[114:115], v[134:135]
v_lshlrev_b32_e64 v136, 16, v34
v_and_b32 v137, 0xffff0000, v34
v_pk_add_f32 v[116:117], v[116:117], v[20:21]
v_pk_add_f32 v[116:117], v[116:117], v[136:137]
v_lshlrev_b32_e64 v138, 16, v35
v_and_b32 v139, 0xffff0000, v35
v_pk_add_f32 v[118:119], v[118:119], v[22:23]
v_pk_add_f32 v[118:119], v[118:119], v[138:139]
v_lshlrev_b32_e64 v140, 16, v36
v_and_b32 v141, 0xffff0000, v36
v_pk_add_f32 v[120:121], v[120:121], v[24:25]
v_pk_add_f32 v[120:121], v[120:121], v[140:141]
v_lshlrev_b32_e64 v142, 16, v37
v_and_b32 v143, 0xffff0000, v37
v_pk_add_f32 v[122:123], v[122:123], v[26:27]
v_pk_add_f32 v[122:123], v[122:123], v[142:143]
s_waitcnt lgkmcnt(4)
v_lshlrev_b32 v8, 16, v192
v_and_b32 v9, 0xffff0000, v192
v_pk_add_f32 v[8:9], v[8:9], v[104:105] neg_lo:[0,1] neg_hi:[0,1]
v_pk_fma_f32 v[104:105], v[8:9], v[156:157], v[104:105]
v_lshlrev_b32_e64 v10, 16, v193
v_and_b32 v11, 0xffff0000, v193
v_pk_add_f32 v[10:11], v[10:11], v[106:107] neg_lo:[0,1] neg_hi:[0,1]
v_pk_fma_f32 v[106:107], v[10:11], v[156:157], v[106:107]
v_cvt_pk_bf16_f32 v104, v104, v105
v_cvt_pk_bf16_f32 v105, v106, v107
ds_write_b64 v241, v[104:105] offset:0
s_waitcnt lgkmcnt(4)
v_lshlrev_b32 v12, 16, v194
v_and_b32 v13, 0xffff0000, v194
v_pk_add_f32 v[12:13], v[12:13], v[108:109] neg_lo:[0,1] neg_hi:[0,1]
v_pk_fma_f32 v[108:109], v[12:13], v[156:157], v[108:109]
v_lshlrev_b32_e64 v14, 16, v195
v_and_b32 v15, 0xffff0000, v195
v_pk_add_f32 v[14:15], v[14:15], v[110:111] neg_lo:[0,1] neg_hi:[0,1]
v_pk_fma_f32 v[110:111], v[14:15], v[156:157], v[110:111]
v_cvt_pk_bf16_f32 v108, v108, v109
v_cvt_pk_bf16_f32 v109, v110, v111
ds_write_b64 v241, v[108:109] offset:32
s_waitcnt lgkmcnt(4)
v_lshlrev_b32 v16, 16, v196
v_and_b32 v17, 0xffff0000, v196
v_pk_add_f32 v[16:17], v[16:17], v[112:113] neg_lo:[0,1] neg_hi:[0,1]
v_pk_fma_f32 v[112:113], v[16:17], v[156:157], v[112:113]
v_lshlrev_b32_e64 v18, 16, v197
v_and_b32 v19, 0xffff0000, v197
v_pk_add_f32 v[18:19], v[18:19], v[114:115] neg_lo:[0,1] neg_hi:[0,1]
v_pk_fma_f32 v[114:115], v[18:19], v[156:157], v[114:115]
v_cvt_pk_bf16_f32 v112, v112, v113
v_cvt_pk_bf16_f32 v113, v114, v115
ds_write_b64 v241, v[112:113] offset:64
s_waitcnt lgkmcnt(4)
v_lshlrev_b32 v20, 16, v198
v_and_b32 v21, 0xffff0000, v198
v_pk_add_f32 v[20:21], v[20:21], v[116:117] neg_lo:[0,1] neg_hi:[0,1]
v_pk_fma_f32 v[116:117], v[20:21], v[156:157], v[116:117]
v_lshlrev_b32_e64 v22, 16, v199
v_and_b32 v23, 0xffff0000, v199
v_pk_add_f32 v[22:23], v[22:23], v[118:119] neg_lo:[0,1] neg_hi:[0,1]
v_pk_fma_f32 v[118:119], v[22:23], v[156:157], v[118:119]
v_cvt_pk_bf16_f32 v116, v116, v117
v_cvt_pk_bf16_f32 v117, v118, v119
ds_write_b64 v241, v[116:117] offset:96
s_waitcnt lgkmcnt(4)
v_lshlrev_b32 v24, 16, v200
v_and_b32 v25, 0xffff0000, v200
v_pk_add_f32 v[24:25], v[24:25], v[120:121] neg_lo:[0,1] neg_hi:[0,1]
v_pk_fma_f32 v[120:121], v[24:25], v[156:157], v[120:121]
v_lshlrev_b32_e64 v26, 16, v201
v_and_b32 v27, 0xffff0000, v201
v_pk_add_f32 v[26:27], v[26:27], v[122:123] neg_lo:[0,1] neg_hi:[0,1]
v_pk_fma_f32 v[122:123], v[26:27], v[156:157], v[122:123]
v_cvt_pk_bf16_f32 v120, v120, v121
v_cvt_pk_bf16_f32 v121, v122, v123
ds_write_b64 v241, v[120:121] offset:128
ds_read_b128 v[160:163], v242
ds_read_b128 v[164:167], v243
ds_read_b128 v[168:171], v244
s_waitcnt lgkmcnt(2)
buffer_store_dwordx4 v[160:163], v245, s[60:63], s27 offen
s_waitcnt lgkmcnt(1)
buffer_store_dwordx4 v[164:167], v246, s[60:63], s27 offen
s_waitcnt lgkmcnt(0)
s_mov_b32 exec_lo, 0xffffffff
s_mov_b32 exec_hi, 0x0
buffer_store_dwordx4 v[168:171], v247, s[60:63], s27 offen
s_or_b32 s73, s2, s3
s_cmp_lg_u32 s73, 0
s_cbranch_scc1 Lnoep
s_mov_b64 exec, -1
s_mov_b32 s86, 0
Lep:
v_cmp_ne_u64_e64 vcc, s[68:69], v[48:49]
v_cmp_ne_u64 s[18:19], s[68:69], v[50:51]
s_nop 0
s_or_b64 vcc, vcc, s[18:19]
v_cmp_ne_u64 s[18:19], s[68:69], v[52:53]
s_nop 0
s_or_b64 vcc, vcc, s[18:19]
v_cmp_ne_u64 s[18:19], s[68:69], v[54:55]
s_nop 0
s_or_b64 vcc, vcc, s[18:19]
v_cmp_ne_u64 s[18:19], s[68:69], v[62:63]
s_nop 0
s_or_b64 vcc, vcc, s[18:19]
v_cmp_ne_u64 s[18:19], s[68:69], v[158:159]
s_nop 0
s_or_b64 vcc, vcc, s[18:19]
s_cbranch_scc0 Lepd
v_min_u32 v6, 13, v2
v_lshlrev_b32_e64 v6, 7, v6
v_lshl_add_u32 v6, v3, 12, v6
v_lshlrev_b32_e64 v7, 6, v1
s_mov_b32 s73, 32768
buffer_load_dwordx2 v[48:49], v6, s[56:59], s73 offen sc1
s_mov_b32 s73, 49152
buffer_load_dwordx2 v[50:51], v6, s[56:59], s73 offen sc1
s_mov_b32 s73, 65536
buffer_load_dwordx2 v[52:53], v6, s[56:59], s73 offen sc1
s_mov_b32 s73, 81920
buffer_load_dwordx2 v[54:55], v6, s[56:59], s73 offen sc1
s_mov_b32 s73, 16384
buffer_load_dwordx2 v[62:63], v7, s[56:59], s73 offen sc1
s_mov_b32 s73, 20480
buffer_load_dwordx2 v[158:159], v7, s[56:59], s73 offen sc1
s_waitcnt vmcnt(0)
s_add_u32 s86, s86, 1
s_cmp_le_u32 s86, 20000
s_cbranch_scc1 Lep
Lepd:
s_mov_b64 exec, 1
buffer_store_dwordx2 v[60:61], off, s[56:59], 0 sc1
Lnoep:
s_endpgm
Lsp_6:
s_mov_b32 s86, 0
Lsp_6x:
s_sleep 4
buffer_load_dwordx2 v[56:57], v229, s[56:59], 0 offen sc1
s_waitcnt vmcnt(0)
v_cmp_ne_u64_e64 vcc, s[68:69], v[56:57]
s_cbranch_vccz Lsd_7
s_add_u32 s86, s86, 1
s_cmp_gt_u32 s86, 20000
s_cbranch_scc1 Lsd_7
s_branch Lsp_6x
Lsp_23:
s_mov_b32 s86, 0
Lsp_23x:
s_sleep 4
buffer_load_dwordx2 v[56:57], v230, s[56:59], 0 offen sc1
s_waitcnt vmcnt(0)
v_cmp_ne_u64 vcc, s[68:69], v[56:57]
s_cbranch_vccz Lsd_24
s_add_u32 s86, s86, 1
s_cmp_gt_u32 s86, 20000
s_cbranch_scc1 Lsd_24
s_branch Lsp_23x
Lsp_25:
s_mov_b32 s86, 0
Lsp_25x:
s_sleep 12
buffer_load_dwordx2 v[56:57], v230, s[56:59], 0 offen sc1
s_waitcnt vmcnt(0)
v_cmp_ne_u64 vcc, s[68:69], v[56:57]
s_cbranch_vccz Lsd_26
s_add_u32 s86, s86, 1
s_cmp_gt_u32 s86, 20000
s_cbranch_scc1 Lsd_26
s_branch Lsp_25x
Lsp_27:
s_mov_b32 s86, 0
Lsp_27x:
s_sleep 4
buffer_load_dwordx2 v[56:57], v229, s[56:59], 0 offen sc1
s_waitcnt vmcnt(0)
v_cmp_ne_u64 vcc, s[68:69], v[56:57]
s_cbranch_vccz Lsd_28
s_add_u32 s86, s86, 1
s_cmp_gt_u32 s86, 20000
s_cbranch_scc1 Lsd_28
s_branch Lsp_27x
Lsp_29:
s_mov_b32 s86, 0
Lsp_29x:
s_sleep 12
buffer_load_dwordx2 v[56:57], v229, s[56:59], 0 offen sc1
s_waitcnt vmcnt(0)
v_cmp_ne_u64 vcc, s[68:69], v[56:57]
s_cbranch_vccz Lsd_30
s_add_u32 s86, s86, 1
s_cmp_gt_u32 s86, 20000
s_cbranch_scc1 Lsd_30
s_branch Lsp_29x
Lsp_31:
s_mov_b32 s86, 0
Lsp_31x:
s_sleep 12
buffer_load_dwordx2 v[56:57], v230, s[56:59], 0 offen sc1
s_waitcnt vmcnt(0)
v_cmp_ne_u64 vcc, s[68:69], v[56:57]
s_cbranch_vccz Lsd_32
s_add_u32 s86, s86, 1
s_cmp_gt_u32 s86, 20000
s_cbranch_scc1 Lsd_32
s_branch Lsp_31x
Lsp_33:
s_mov_b32 s86, 0
Lsp_33x:
s_sleep 4
buffer_load_dwordx2 v[56:57], v235, s[56:59], 0 offen sc1
s_waitcnt vmcnt(0)
v_cmp_ne_u64 vcc, s[68:69], v[56:57]
s_cbranch_vccz Lsd_34
s_add_u32 s86, s86, 1
s_cmp_gt_u32 s86, 20000
s_cbranch_scc1 Lsd_34
s_branch Lsp_33x
Lend:
s_endpgm
.section .rodata,"a"
.p2align 6
.amdhsa_kernel gated_mix__ssm_conv_s4__dense_activation_relu__prompt_kernel
  .amdhsa_next_free_vgpr 512
  .amdhsa_next_free_sgpr 102
  .amdhsa_accum_offset 256
  .amdhsa_group_segment_fixed_size 0
  .amdhsa_kernarg_size 128
  .amdhsa_user_sgpr_count 2
  .amdhsa_user_sgpr_kernarg_segment_ptr 1
  .amdhsa_system_sgpr_workgroup_id_x 1
.end_amdhsa_kernel
```
